```python
import torch

def _softmax(x, axis=-1):
    return torch.softmax(x, dim=axis)
def _gelu(x):
    return torch.nn.functional.gelu(x, approximate="tanh")
def _silu(x):
    return torch.nn.functional.silu(x)
def _sigmoid(x):
    return torch.sigmoid(x)
def _layernorm(x, axis=-1, eps=1e-5):
    m = x.mean(dim=axis, keepdim=True)
    v = x.var(dim=axis, keepdim=True, unbiased=False)
    return (x - m) / torch.sqrt(v + eps)
def _scatter_add(tgt, idx, src, axis=0):
    return tgt.clone().index_add_(axis, idx, src)
def _segment_sum(src, seg, n):
    out = torch.zeros((n,) + src.shape[1:], dtype=src.dtype)
    return out.index_add_(0, seg, src)
def _pad(x, pw):
    flat = tuple(v for pair in reversed(pw) for v in pair)
    return torch.nn.functional.pad(x, flat)

kernel_name = 'sequential_preLN__spectral_gfnet__dense_activation_squared_relu__prompt'

def setup_inputs():

    _w = (lambda a: (lambda t: t.to(torch.bfloat16) if t.is_floating_point() else t)(torch.as_tensor(a)))
    def _A_setup():
        B, S, D = 1, 2048, 640
        Df = D // 2 + 1
        return {
            "x": _w((lambda *s: torch.randn(*s, dtype=torch.bfloat16) * 0.05)(B, S, D)),
            "w_r": _w((lambda *s: torch.randn(*s, dtype=torch.bfloat16) * 0.4)(S, Df) * 0.02),
            "w_i": _w((lambda *s: torch.randn(*s, dtype=torch.bfloat16) * 0.4)(S, Df) * 0.02),
        }
    _A_in = _A_setup()

    def _B_setup():
        B, S, D, F = 1, 2048, 640, 1536
        return {
            "x": _w((lambda *s: torch.randn(*s, dtype=torch.bfloat16) * 0.05)(B, S, D)),
            "w1": _w((lambda *s: torch.randn(*s, dtype=torch.bfloat16) * 0.05)(D, F)),
            "b1": _w((lambda *s: torch.randn(*s, dtype=torch.bfloat16) * 0.2)(F)),
            "w2": _w((lambda *s: torch.randn(*s, dtype=torch.bfloat16) * 0.05)(F, D)),
            "b2": _w((lambda *s: torch.randn(*s, dtype=torch.bfloat16) * 1.6)(D)),
        }
    _B_in = _B_setup()

    return {
        "A_x": _A_in["x"],
        "A_w_r": _A_in["w_r"],
        "A_w_i": _A_in["w_i"],
        "B_x": _B_in["x"],
        "B_w1": _B_in["w1"],
        "B_b1": _B_in["b1"],
        "B_w2": _B_in["w2"],
        "B_b2": _B_in["b2"],
    }

def reference(A_x, A_w_r, A_w_i, B_x, B_w1, B_b1, B_w2, B_b2):
    def _A_ref(x, w_r, w_i):
        B, S, D = x.shape
        X = (lambda x, axes=(-2,-1): torch.fft.rfft2(x.float(), dim=axes))(x, axes=(-2, -1))
        W = w_r + 1j * w_i
        X = X * W
        y = (lambda x, s, axes=(-2,-1): torch.fft.irfft2(x, s=s, dim=axes).to(torch.bfloat16))(X, (S, D), axes=(-2, -1))
        return y

    def _B_ref(x, w1, b1, w2, b2):
        h = torch.einsum("bsd,df->bsf", x, w1) + b1
        zero = torch.zeros_like(h)
        r = torch.where(h > zero, h, zero)
        h = r * r
        out = torch.einsum("bsf,fd->bsd", h, w2) + b2
        return out

    x = A_x
    h = x + _A_ref(_layernorm(x, axis=-1), A_w_r, A_w_i)
    h2 = h + _B_ref(_layernorm(h, axis=-1), B_w1, B_b1, B_w2, B_b2)
    return h2
```

```asm
; @launch kernel=k1_rowfft_kernel grid=(640,1,1) block=(320,1,1) lds=49664
; @launch kernel=k2_colfft_kernel grid=(321,1,1) block=(256,1,1) lds=36864
; @launch kernel=k3_rowifft_kernel grid=(256,1,1) block=(320,1,1) lds=49664
; @launch kernel=k4_gemm1_kernel grid=(256,1,1) block=(512,1,1) lds=143360
; @launch kernel=k5_gemm2_kernel grid=(256,1,1) block=(512,1,1) lds=147456
.amdgcn_target "amdgcn-amd-amdhsa--gfx950"
.text
.globl k1_rowfft_kernel
.p2align 8
.type k1_rowfft_kernel,@function
k1_rowfft_kernel:
    s_cmp_ge_u32 s2, 640
    s_cbranch_scc1 .Lk1_end
    s_load_dwordx8 s[16:23], s[0:1], 0
    s_load_dwordx2 s[24:25], s[0:1], 80
    s_mov_b32 s56, 0x3f3504f3
    s_mov_b32 s57, 0x3f3504f3
    s_mov_b32 s58, 0x3e9e377a
    s_mov_b32 s59, 0x3e9e377a
    s_mov_b32 s60, 0xbf4f1bbd
    s_mov_b32 s61, 0xbf4f1bbd
    s_mov_b32 s62, 0x3f737871
    s_mov_b32 s63, 0x3f737871
    s_mov_b32 s64, 0x3f167918
    s_mov_b32 s65, 0x3f167918
    s_mov_b32 s68, 0x07060302
    s_mov_b32 s66, 0x3acccccd
    s_mov_b32 s67, 0x44200000
    v_lshrrev_b32 v1, 6, v0
    s_waitcnt lgkmcnt(0)
    v_readfirstlane_b32 s3, v1
    s_mov_b32 s40, s24
    s_and_b32 s41, s25, 0xffff
    s_mov_b32 s42, 0x2000000
    s_mov_b32 s43, 0x00020000
    s_cmp_ge_u32 s2, 256
    s_cbranch_scc1 .Lk1_wt
    s_mov_b32 s36, s16
    s_and_b32 s37, s17, 0xffff
    s_mov_b32 s38, 0x280000
    s_mov_b32 s39, 0x00020000
    v_mul_u32_u24 v1, 205, v0
    v_lshrrev_b32 v1, 14, v1
    v_mul_u32_u24 v2, 80, v1
    v_sub_u32 v2, v0, v2
    v_mul_u32_u24 v3, 205, v2
    v_lshrrev_b32 v3, 11, v3
    v_mul_u32_u24 v4, 10, v3
    v_sub_u32 v4, v2, v4
    v_cvt_f32_u32 v8, v2
    v_mul_f32 v8, 0xbacccccd, v8
    v_mul_f32 v11, 1.0, v8
    v_mul_f32 v13, 2.0, v8
    v_mul_f32 v15, 0x40400000, v8
    v_mul_f32 v17, 4.0, v8
    v_mul_f32 v19, 0x40a00000, v8
    v_mul_f32 v21, 0x40c00000, v8
    v_mul_f32 v23, 0x40e00000, v8
    v_cos_f32 v10, v11
    v_sin_f32 v11, v11
    v_cos_f32 v12, v13
    v_sin_f32 v13, v13
    v_cos_f32 v14, v15
    v_sin_f32 v15, v15
    v_cos_f32 v16, v17
    v_sin_f32 v17, v17
    v_cos_f32 v18, v19
    v_sin_f32 v19, v19
    v_cos_f32 v20, v21
    v_sin_f32 v21, v21
    v_cos_f32 v22, v23
    v_sin_f32 v23, v23
    v_cvt_f32_u32 v24, v4
    v_mul_f32 v24, 0xbc4ccccd, v24
    v_mul_f32 v27, 1.0, v24
    v_mul_f32 v29, 2.0, v24
    v_mul_f32 v31, 0x40400000, v24
    v_mul_f32 v33, 4.0, v24
    v_mul_f32 v35, 0x40a00000, v24
    v_mul_f32 v37, 0x40c00000, v24
    v_mul_f32 v39, 0x40e00000, v24
    v_cos_f32 v26, v27
    v_sin_f32 v27, v27
    v_cos_f32 v28, v29
    v_sin_f32 v29, v29
    v_cos_f32 v30, v31
    v_sin_f32 v31, v31
    v_cos_f32 v32, v33
    v_sin_f32 v33, v33
    v_cos_f32 v34, v35
    v_sin_f32 v35, v35
    v_cos_f32 v36, v37
    v_sin_f32 v37, v37
    v_cos_f32 v38, v39
    v_sin_f32 v39, v39
    s_cmp_ge_u32 s3, 4
    s_cbranch_scc1 .Lk1_b0
    v_and_b32 v5, 63, v0
    s_lshl_b32 s4, s2, 3
    s_lshl_b32 s5, s3, 1
    s_add_u32 s4, s4, s5
    s_mul_i32 s4, s4, 1280
    v_mul_u32_u24 v6, 20, v5
    buffer_load_dwordx4 v[40:43], v6, s[36:39], s4 offen
    buffer_load_dword v44, v6, s[36:39], s4 offen offset:16
    buffer_load_dwordx4 v[48:51], v6, s[36:39], s4 offen offset:1280
    buffer_load_dword v45, v6, s[36:39], s4 offen offset:1296
    s_waitcnt vmcnt(0)
    v_lshlrev_b32 v52, 16, v40
    v_and_b32 v54, 0xffff0000, v40
    v_lshlrev_b32 v53, 16, v48
    v_and_b32 v55, 0xffff0000, v48
    v_lshlrev_b32 v56, 16, v41
    v_and_b32 v58, 0xffff0000, v41
    v_lshlrev_b32 v57, 16, v49
    v_and_b32 v59, 0xffff0000, v49
    v_lshlrev_b32 v60, 16, v42
    v_and_b32 v62, 0xffff0000, v42
    v_lshlrev_b32 v61, 16, v50
    v_and_b32 v63, 0xffff0000, v50
    v_lshlrev_b32 v64, 16, v43
    v_and_b32 v66, 0xffff0000, v43
    v_lshlrev_b32 v65, 16, v51
    v_and_b32 v67, 0xffff0000, v51
    v_lshlrev_b32 v68, 16, v44
    v_and_b32 v70, 0xffff0000, v44
    v_lshlrev_b32 v69, 16, v45
    v_and_b32 v71, 0xffff0000, v45
    v_add_f32 v7, v52, v54
    v_add_f32 v7, v7, v56
    v_add_f32 v7, v7, v58
    v_add_f32 v7, v7, v60
    v_add_f32 v7, v7, v62
    v_add_f32 v7, v7, v64
    v_add_f32 v7, v7, v66
    v_add_f32 v7, v7, v68
    v_add_f32 v7, v7, v70
    v_add_f32 v40, v53, v55
    v_add_f32 v40, v40, v57
    v_add_f32 v40, v40, v59
    v_add_f32 v40, v40, v61
    v_add_f32 v40, v40, v63
    v_add_f32 v40, v40, v65
    v_add_f32 v40, v40, v67
    v_add_f32 v40, v40, v69
    v_add_f32 v40, v40, v71
    v_add_f32_dpp v7, v7, v7 quad_perm:[1,0,3,2] row_mask:0xf bank_mask:0xf
    s_nop 0
    v_add_f32_dpp v40, v40, v40 quad_perm:[1,0,3,2] row_mask:0xf bank_mask:0xf
    v_add_f32_dpp v7, v7, v7 quad_perm:[2,3,0,1] row_mask:0xf bank_mask:0xf
    s_nop 0
    v_add_f32_dpp v40, v40, v40 quad_perm:[2,3,0,1] row_mask:0xf bank_mask:0xf
    v_add_f32_dpp v7, v7, v7 row_half_mirror row_mask:0xf bank_mask:0xf
    s_nop 0
    v_add_f32_dpp v40, v40, v40 row_half_mirror row_mask:0xf bank_mask:0xf
    v_add_f32_dpp v7, v7, v7 row_mirror row_mask:0xf bank_mask:0xf
    s_nop 0
    v_add_f32_dpp v40, v40, v40 row_mirror row_mask:0xf bank_mask:0xf
    v_readlane_b32 s70, v7, 0
    v_readlane_b32 s71, v7, 16
    v_readlane_b32 s72, v7, 32
    v_readlane_b32 s73, v7, 48
    v_readlane_b32 s74, v40, 0
    v_readlane_b32 s75, v40, 16
    v_readlane_b32 s76, v40, 32
    v_readlane_b32 s77, v40, 48
    v_mov_b32 v7, s70
    v_add_f32 v7, s71, v7
    v_mov_b32 v41, s72
    v_add_f32 v41, s73, v41
    v_add_f32 v7, v7, v41
    v_mov_b32 v40, s74
    v_add_f32 v40, s75, v40
    v_mov_b32 v41, s76
    v_add_f32 v41, s77, v41
    v_add_f32 v40, v40, v41
    v_mul_f32 v41, s66, v7
    v_fma_f32 v42, -v41, s67, v7
    v_fma_f32 v41, v42, s66, v41
    v_mul_f32 v7, s66, v40
    v_fma_f32 v42, -v7, s67, v40
    v_fma_f32 v7, v42, s66, v7
    v_sub_f32 v42, v52, v41
    v_mul_f32 v40, v42, v42
    v_sub_f32 v42, v54, v41
    v_fmac_f32 v40, v42, v42
    v_sub_f32 v42, v56, v41
    v_fmac_f32 v40, v42, v42
    v_sub_f32 v42, v58, v41
    v_fmac_f32 v40, v42, v42
    v_sub_f32 v42, v60, v41
    v_fmac_f32 v40, v42, v42
    v_sub_f32 v42, v62, v41
    v_fmac_f32 v40, v42, v42
    v_sub_f32 v42, v64, v41
    v_fmac_f32 v40, v42, v42
    v_sub_f32 v42, v66, v41
    v_fmac_f32 v40, v42, v42
    v_sub_f32 v42, v68, v41
    v_fmac_f32 v40, v42, v42
    v_sub_f32 v42, v70, v41
    v_fmac_f32 v40, v42, v42
    v_sub_f32 v43, v53, v7
    v_mul_f32 v42, v43, v43
    v_sub_f32 v43, v55, v7
    v_fmac_f32 v42, v43, v43
    v_sub_f32 v43, v57, v7
    v_fmac_f32 v42, v43, v43
    v_sub_f32 v43, v59, v7
    v_fmac_f32 v42, v43, v43
    v_sub_f32 v43, v61, v7
    v_fmac_f32 v42, v43, v43
    v_sub_f32 v43, v63, v7
    v_fmac_f32 v42, v43, v43
    v_sub_f32 v43, v65, v7
    v_fmac_f32 v42, v43, v43
    v_sub_f32 v43, v67, v7
    v_fmac_f32 v42, v43, v43
    v_sub_f32 v43, v69, v7
    v_fmac_f32 v42, v43, v43
    v_sub_f32 v43, v71, v7
    v_fmac_f32 v42, v43, v43
    v_add_f32_dpp v40, v40, v40 quad_perm:[1,0,3,2] row_mask:0xf bank_mask:0xf
    s_nop 0
    v_add_f32_dpp v42, v42, v42 quad_perm:[1,0,3,2] row_mask:0xf bank_mask:0xf
    v_add_f32_dpp v40, v40, v40 quad_perm:[2,3,0,1] row_mask:0xf bank_mask:0xf
    s_nop 0
    v_add_f32_dpp v42, v42, v42 quad_perm:[2,3,0,1] row_mask:0xf bank_mask:0xf
    v_add_f32_dpp v40, v40, v40 row_half_mirror row_mask:0xf bank_mask:0xf
    s_nop 0
    v_add_f32_dpp v42, v42, v42 row_half_mirror row_mask:0xf bank_mask:0xf
    v_add_f32_dpp v40, v40, v40 row_mirror row_mask:0xf bank_mask:0xf
    s_nop 0
    v_add_f32_dpp v42, v42, v42 row_mirror row_mask:0xf bank_mask:0xf
    v_readlane_b32 s70, v40, 0
    v_readlane_b32 s71, v40, 16
    v_readlane_b32 s72, v40, 32
    v_readlane_b32 s73, v40, 48
    v_readlane_b32 s74, v42, 0
    v_readlane_b32 s75, v42, 16
    v_readlane_b32 s76, v42, 32
    v_readlane_b32 s77, v42, 48
    v_mov_b32 v40, s70
    v_add_f32 v40, s71, v40
    v_mov_b32 v43, s72
    v_add_f32 v43, s73, v43
    v_add_f32 v40, v40, v43
    v_mov_b32 v42, s74
    v_add_f32 v42, s75, v42
    v_mov_b32 v43, s76
    v_add_f32 v43, s77, v43
    v_add_f32 v42, v42, v43
    v_mul_f32 v43, s66, v40
    v_fma_f32 v44, -v43, s67, v40
    v_fma_f32 v43, v44, s66, v43
    v_cvt_pk_bf16_f32 v43, v43, v43
    v_lshlrev_b32 v43, 16, v43
    v_add_f32 v43, 0x3727c5ac, v43
    v_cvt_pk_bf16_f32 v43, v43, v43
    v_lshlrev_b32 v43, 16, v43
    v_sqrt_f32 v43, v43
    s_nop 0
    v_cvt_pk_bf16_f32 v43, v43, v43
    v_lshlrev_b32 v43, 16, v43
    v_rcp_f32 v43, v43
    v_cvt_pk_bf16_f32 v41, v41, v41
    v_lshlrev_b32 v41, 16, v41
    v_sub_f32 v52, v52, v41
    v_sub_f32 v54, v54, v41
    v_cvt_pk_bf16_f32 v44, v52, v54
    v_lshlrev_b32 v52, 16, v44
    v_and_b32 v54, 0xffff0000, v44
    v_mul_f32 v52, v52, v43
    v_mul_f32 v54, v54, v43
    v_cvt_pk_bf16_f32 v44, v52, v54
    v_lshlrev_b32 v52, 16, v44
    v_and_b32 v54, 0xffff0000, v44
    v_sub_f32 v56, v56, v41
    v_sub_f32 v58, v58, v41
    v_cvt_pk_bf16_f32 v44, v56, v58
    v_lshlrev_b32 v56, 16, v44
    v_and_b32 v58, 0xffff0000, v44
    v_mul_f32 v56, v56, v43
    v_mul_f32 v58, v58, v43
    v_cvt_pk_bf16_f32 v44, v56, v58
    v_lshlrev_b32 v56, 16, v44
    v_and_b32 v58, 0xffff0000, v44
    v_sub_f32 v60, v60, v41
    v_sub_f32 v62, v62, v41
    v_cvt_pk_bf16_f32 v44, v60, v62
    v_lshlrev_b32 v60, 16, v44
    v_and_b32 v62, 0xffff0000, v44
    v_mul_f32 v60, v60, v43
    v_mul_f32 v62, v62, v43
    v_cvt_pk_bf16_f32 v44, v60, v62
    v_lshlrev_b32 v60, 16, v44
    v_and_b32 v62, 0xffff0000, v44
    v_sub_f32 v64, v64, v41
    v_sub_f32 v66, v66, v41
    v_cvt_pk_bf16_f32 v44, v64, v66
    v_lshlrev_b32 v64, 16, v44
    v_and_b32 v66, 0xffff0000, v44
    v_mul_f32 v64, v64, v43
    v_mul_f32 v66, v66, v43
    v_cvt_pk_bf16_f32 v44, v64, v66
    v_lshlrev_b32 v64, 16, v44
    v_and_b32 v66, 0xffff0000, v44
    v_sub_f32 v68, v68, v41
    v_sub_f32 v70, v70, v41
    v_cvt_pk_bf16_f32 v44, v68, v70
    v_lshlrev_b32 v68, 16, v44
    v_and_b32 v70, 0xffff0000, v44
    v_mul_f32 v68, v68, v43
    v_mul_f32 v70, v70, v43
    v_cvt_pk_bf16_f32 v44, v68, v70
    v_lshlrev_b32 v68, 16, v44
    v_and_b32 v70, 0xffff0000, v44
    v_mul_f32 v40, s66, v42
    v_fma_f32 v41, -v40, s67, v42
    v_fma_f32 v40, v41, s66, v40
    v_cvt_pk_bf16_f32 v40, v40, v40
    v_lshlrev_b32 v40, 16, v40
    v_add_f32 v40, 0x3727c5ac, v40
    v_cvt_pk_bf16_f32 v40, v40, v40
    v_lshlrev_b32 v40, 16, v40
    v_sqrt_f32 v40, v40
    s_nop 0
    v_cvt_pk_bf16_f32 v40, v40, v40
    v_lshlrev_b32 v40, 16, v40
    v_rcp_f32 v40, v40
    v_cvt_pk_bf16_f32 v7, v7, v7
    v_lshlrev_b32 v7, 16, v7
    v_sub_f32 v53, v53, v7
    v_sub_f32 v55, v55, v7
    v_cvt_pk_bf16_f32 v41, v53, v55
    v_lshlrev_b32 v53, 16, v41
    v_and_b32 v55, 0xffff0000, v41
    v_mul_f32 v53, v53, v40
    v_mul_f32 v55, v55, v40
    v_cvt_pk_bf16_f32 v41, v53, v55
    v_lshlrev_b32 v53, 16, v41
    v_and_b32 v55, 0xffff0000, v41
    v_sub_f32 v57, v57, v7
    v_sub_f32 v59, v59, v7
    v_cvt_pk_bf16_f32 v41, v57, v59
    v_lshlrev_b32 v57, 16, v41
    v_and_b32 v59, 0xffff0000, v41
    v_mul_f32 v57, v57, v40
    v_mul_f32 v59, v59, v40
    v_cvt_pk_bf16_f32 v41, v57, v59
    v_lshlrev_b32 v57, 16, v41
    v_and_b32 v59, 0xffff0000, v41
    v_sub_f32 v61, v61, v7
    v_sub_f32 v63, v63, v7
    v_cvt_pk_bf16_f32 v41, v61, v63
    v_lshlrev_b32 v61, 16, v41
    v_and_b32 v63, 0xffff0000, v41
    v_mul_f32 v61, v61, v40
    v_mul_f32 v63, v63, v40
    v_cvt_pk_bf16_f32 v41, v61, v63
    v_lshlrev_b32 v61, 16, v41
    v_and_b32 v63, 0xffff0000, v41
    v_sub_f32 v65, v65, v7
    v_sub_f32 v67, v67, v7
    v_cvt_pk_bf16_f32 v41, v65, v67
    v_lshlrev_b32 v65, 16, v41
    v_and_b32 v67, 0xffff0000, v41
    v_mul_f32 v65, v65, v40
    v_mul_f32 v67, v67, v40
    v_cvt_pk_bf16_f32 v41, v65, v67
    v_lshlrev_b32 v65, 16, v41
    v_and_b32 v67, 0xffff0000, v41
    v_sub_f32 v69, v69, v7
    v_sub_f32 v71, v71, v7
    v_cvt_pk_bf16_f32 v41, v69, v71
    v_lshlrev_b32 v69, 16, v41
    v_and_b32 v71, 0xffff0000, v41
    v_mul_f32 v69, v69, v40
    v_mul_f32 v71, v71, v40
    v_cvt_pk_bf16_f32 v41, v69, v71
    v_lshlrev_b32 v69, 16, v41
    v_and_b32 v71, 0xffff0000, v41
    s_mul_i32 s5, s3, 5120
    v_mul_u32_u24 v6, 80, v5
    v_add_u32 v6, s5, v6
    ds_write_b128 v6, v[52:55] offset:0
    ds_write_b128 v6, v[56:59] offset:16
    ds_write_b128 v6, v[60:63] offset:32
    ds_write_b128 v6, v[64:67] offset:48
    ds_write_b128 v6, v[68:71] offset:64
.Lk1_b0:
    s_waitcnt lgkmcnt(0)
    s_barrier
    v_mul_u32_u24 v5, 640, v1
    v_add_u32 v5, v5, v2
    v_lshlrev_b32 v5, 3, v5
    ds_read_b64 v[40:41], v5 offset:0
    ds_read_b64 v[42:43], v5 offset:640
    ds_read_b64 v[44:45], v5 offset:1280
    ds_read_b64 v[46:47], v5 offset:1920
    ds_read_b64 v[48:49], v5 offset:2560
    ds_read_b64 v[50:51], v5 offset:3200
    ds_read_b64 v[52:53], v5 offset:3840
    ds_read_b64 v[54:55], v5 offset:4480
    v_mul_u32_u24 v5, 848, v1
    v_add_u32 v5, v5, v2
    v_lshlrev_b32 v5, 3, v5
    s_waitcnt vmcnt(0) lgkmcnt(0)
    v_pk_add_f32 v[56:57], v[40:41], v[48:49]
    v_pk_add_f32 v[58:59], v[40:41], v[48:49] neg_lo:[0,1] neg_hi:[0,1]
    v_pk_add_f32 v[40:41], v[42:43], v[50:51]
    v_pk_add_f32 v[48:49], v[42:43], v[50:51] neg_lo:[0,1] neg_hi:[0,1]
    v_pk_add_f32 v[42:43], v[44:45], v[52:53]
    v_pk_add_f32 v[50:51], v[44:45], v[52:53] neg_lo:[0,1] neg_hi:[0,1]
    v_pk_add_f32 v[44:45], v[46:47], v[54:55]
    v_pk_add_f32 v[52:53], v[46:47], v[54:55] neg_lo:[0,1] neg_hi:[0,1]
    v_pk_add_f32 v[46:47], v[48:49], v[48:49] op_sel:[0,1] op_sel_hi:[1,0] neg_hi:[0,1]
    v_pk_mul_f32 v[46:47], v[46:47], s[56:57]
    v_pk_add_f32 v[48:49], v[52:53], v[52:53] op_sel:[0,1] op_sel_hi:[1,0] neg_lo:[1,0] neg_hi:[1,1]
    v_pk_mul_f32 v[48:49], v[48:49], s[56:57]
    v_pk_add_f32 v[52:53], v[56:57], v[42:43]
    v_pk_add_f32 v[54:55], v[56:57], v[42:43] neg_lo:[0,1] neg_hi:[0,1]
    v_pk_add_f32 v[42:43], v[40:41], v[44:45]
    v_pk_add_f32 v[56:57], v[40:41], v[44:45] neg_lo:[0,1] neg_hi:[0,1]
    v_pk_add_f32 v[40:41], v[52:53], v[42:43]
    v_pk_add_f32 v[44:45], v[52:53], v[42:43] neg_lo:[0,1] neg_hi:[0,1]
    v_pk_add_f32 v[42:43], v[54:55], v[56:57] op_sel:[0,1] op_sel_hi:[1,0] neg_hi:[0,1]
    v_pk_add_f32 v[52:53], v[54:55], v[56:57] op_sel:[0,1] op_sel_hi:[1,0] neg_lo:[0,1]
    v_pk_add_f32 v[54:55], v[58:59], v[50:51] op_sel:[0,1] op_sel_hi:[1,0] neg_hi:[0,1]
    v_pk_add_f32 v[56:57], v[58:59], v[50:51] op_sel:[0,1] op_sel_hi:[1,0] neg_lo:[0,1]
    v_pk_add_f32 v[50:51], v[46:47], v[48:49]
    v_pk_add_f32 v[58:59], v[46:47], v[48:49] neg_lo:[0,1] neg_hi:[0,1]
    v_pk_add_f32 v[46:47], v[54:55], v[50:51]
    v_pk_add_f32 v[48:49], v[54:55], v[50:51] neg_lo:[0,1] neg_hi:[0,1]
    v_pk_add_f32 v[50:51], v[56:57], v[58:59] op_sel:[0,1] op_sel_hi:[1,0] neg_hi:[0,1]
    v_pk_add_f32 v[54:55], v[56:57], v[58:59] op_sel:[0,1] op_sel_hi:[1,0] neg_lo:[0,1]
    ds_write_b64 v5, v[40:41] offset:22528
    v_pk_mul_f32 v[40:41], v[46:47], v[10:11] op_sel_hi:[0,1]
    v_pk_fma_f32 v[40:41], v[46:47], v[10:11], v[40:41] op_sel:[1,1,0] op_sel_hi:[1,0,1] neg_lo:[0,1,0]
    ds_write_b64 v5, v[40:41] offset:23376
    v_pk_mul_f32 v[40:41], v[42:43], v[12:13] op_sel_hi:[0,1]
    v_pk_fma_f32 v[40:41], v[42:43], v[12:13], v[40:41] op_sel:[1,1,0] op_sel_hi:[1,0,1] neg_lo:[0,1,0]
    ds_write_b64 v5, v[40:41] offset:24224
    v_pk_mul_f32 v[40:41], v[50:51], v[14:15] op_sel_hi:[0,1]
    v_pk_fma_f32 v[40:41], v[50:51], v[14:15], v[40:41] op_sel:[1,1,0] op_sel_hi:[1,0,1] neg_lo:[0,1,0]
    ds_write_b64 v5, v[40:41] offset:25072
    v_pk_mul_f32 v[40:41], v[44:45], v[16:17] op_sel_hi:[0,1]
    v_pk_fma_f32 v[40:41], v[44:45], v[16:17], v[40:41] op_sel:[1,1,0] op_sel_hi:[1,0,1] neg_lo:[0,1,0]
    ds_write_b64 v5, v[40:41] offset:25920
    v_pk_mul_f32 v[40:41], v[48:49], v[18:19] op_sel_hi:[0,1]
    v_pk_fma_f32 v[40:41], v[48:49], v[18:19], v[40:41] op_sel:[1,1,0] op_sel_hi:[1,0,1] neg_lo:[0,1,0]
    ds_write_b64 v5, v[40:41] offset:26768
    v_pk_mul_f32 v[40:41], v[52:53], v[20:21] op_sel_hi:[0,1]
    v_pk_fma_f32 v[40:41], v[52:53], v[20:21], v[40:41] op_sel:[1,1,0] op_sel_hi:[1,0,1] neg_lo:[0,1,0]
    ds_write_b64 v5, v[40:41] offset:27616
    v_pk_mul_f32 v[40:41], v[54:55], v[22:23] op_sel_hi:[0,1]
    v_pk_fma_f32 v[40:41], v[54:55], v[22:23], v[40:41] op_sel:[1,1,0] op_sel_hi:[1,0,1] neg_lo:[0,1,0]
    ds_write_b64 v5, v[40:41] offset:28464
    s_waitcnt lgkmcnt(0)
    s_barrier
    v_mul_u32_u24 v5, 848, v1
    v_mul_u32_u24 v6, 106, v3
    v_add3_u32 v5, v5, v6, v4
    v_lshlrev_b32 v5, 3, v5
    ds_read_b64 v[40:41], v5 offset:22528
    ds_read_b64 v[42:43], v5 offset:22608
    ds_read_b64 v[44:45], v5 offset:22688
    ds_read_b64 v[46:47], v5 offset:22768
    ds_read_b64 v[48:49], v5 offset:22848
    ds_read_b64 v[50:51], v5 offset:22928
    ds_read_b64 v[52:53], v5 offset:23008
    ds_read_b64 v[54:55], v5 offset:23088
    v_mul_u32_u24 v5, 704, v1
    v_mul_u32_u24 v6, 11, v3
    v_add3_u32 v5, v5, v6, v4
    v_lshlrev_b32 v5, 3, v5
    s_waitcnt lgkmcnt(0)
    v_pk_add_f32 v[56:57], v[40:41], v[48:49]
    v_pk_add_f32 v[58:59], v[40:41], v[48:49] neg_lo:[0,1] neg_hi:[0,1]
    v_pk_add_f32 v[40:41], v[42:43], v[50:51]
    v_pk_add_f32 v[48:49], v[42:43], v[50:51] neg_lo:[0,1] neg_hi:[0,1]
    v_pk_add_f32 v[42:43], v[44:45], v[52:53]
    v_pk_add_f32 v[50:51], v[44:45], v[52:53] neg_lo:[0,1] neg_hi:[0,1]
    v_pk_add_f32 v[44:45], v[46:47], v[54:55]
    v_pk_add_f32 v[52:53], v[46:47], v[54:55] neg_lo:[0,1] neg_hi:[0,1]
    v_pk_add_f32 v[46:47], v[48:49], v[48:49] op_sel:[0,1] op_sel_hi:[1,0] neg_hi:[0,1]
    v_pk_mul_f32 v[46:47], v[46:47], s[56:57]
    v_pk_add_f32 v[48:49], v[52:53], v[52:53] op_sel:[0,1] op_sel_hi:[1,0] neg_lo:[1,0] neg_hi:[1,1]
    v_pk_mul_f32 v[48:49], v[48:49], s[56:57]
    v_pk_add_f32 v[52:53], v[56:57], v[42:43]
    v_pk_add_f32 v[54:55], v[56:57], v[42:43] neg_lo:[0,1] neg_hi:[0,1]
    v_pk_add_f32 v[42:43], v[40:41], v[44:45]
    v_pk_add_f32 v[56:57], v[40:41], v[44:45] neg_lo:[0,1] neg_hi:[0,1]
    v_pk_add_f32 v[40:41], v[52:53], v[42:43]
    v_pk_add_f32 v[44:45], v[52:53], v[42:43] neg_lo:[0,1] neg_hi:[0,1]
    v_pk_add_f32 v[42:43], v[54:55], v[56:57] op_sel:[0,1] op_sel_hi:[1,0] neg_hi:[0,1]
    v_pk_add_f32 v[52:53], v[54:55], v[56:57] op_sel:[0,1] op_sel_hi:[1,0] neg_lo:[0,1]
    v_pk_add_f32 v[54:55], v[58:59], v[50:51] op_sel:[0,1] op_sel_hi:[1,0] neg_hi:[0,1]
    v_pk_add_f32 v[56:57], v[58:59], v[50:51] op_sel:[0,1] op_sel_hi:[1,0] neg_lo:[0,1]
    v_pk_add_f32 v[50:51], v[46:47], v[48:49]
    v_pk_add_f32 v[58:59], v[46:47], v[48:49] neg_lo:[0,1] neg_hi:[0,1]
    v_pk_add_f32 v[46:47], v[54:55], v[50:51]
    v_pk_add_f32 v[48:49], v[54:55], v[50:51] neg_lo:[0,1] neg_hi:[0,1]
    v_pk_add_f32 v[50:51], v[56:57], v[58:59] op_sel:[0,1] op_sel_hi:[1,0] neg_hi:[0,1]
    v_pk_add_f32 v[54:55], v[56:57], v[58:59] op_sel:[0,1] op_sel_hi:[1,0] neg_lo:[0,1]
    ds_write_b64 v5, v[40:41] offset:0
    v_pk_mul_f32 v[40:41], v[46:47], v[26:27] op_sel_hi:[0,1]
    v_pk_fma_f32 v[40:41], v[46:47], v[26:27], v[40:41] op_sel:[1,1,0] op_sel_hi:[1,0,1] neg_lo:[0,1,0]
    ds_write_b64 v5, v[40:41] offset:704
    v_pk_mul_f32 v[40:41], v[42:43], v[28:29] op_sel_hi:[0,1]
    v_pk_fma_f32 v[40:41], v[42:43], v[28:29], v[40:41] op_sel:[1,1,0] op_sel_hi:[1,0,1] neg_lo:[0,1,0]
    ds_write_b64 v5, v[40:41] offset:1408
    v_pk_mul_f32 v[40:41], v[50:51], v[30:31] op_sel_hi:[0,1]
    v_pk_fma_f32 v[40:41], v[50:51], v[30:31], v[40:41] op_sel:[1,1,0] op_sel_hi:[1,0,1] neg_lo:[0,1,0]
    ds_write_b64 v5, v[40:41] offset:2112
    v_pk_mul_f32 v[40:41], v[44:45], v[32:33] op_sel_hi:[0,1]
    v_pk_fma_f32 v[40:41], v[44:45], v[32:33], v[40:41] op_sel:[1,1,0] op_sel_hi:[1,0,1] neg_lo:[0,1,0]
    ds_write_b64 v5, v[40:41] offset:2816
    v_pk_mul_f32 v[40:41], v[48:49], v[34:35] op_sel_hi:[0,1]
    v_pk_fma_f32 v[40:41], v[48:49], v[34:35], v[40:41] op_sel:[1,1,0] op_sel_hi:[1,0,1] neg_lo:[0,1,0]
    ds_write_b64 v5, v[40:41] offset:3520
    v_pk_mul_f32 v[40:41], v[52:53], v[36:37] op_sel_hi:[0,1]
    v_pk_fma_f32 v[40:41], v[52:53], v[36:37], v[40:41] op_sel:[1,1,0] op_sel_hi:[1,0,1] neg_lo:[0,1,0]
    ds_write_b64 v5, v[40:41] offset:4224
    v_pk_mul_f32 v[40:41], v[54:55], v[38:39] op_sel_hi:[0,1]
    v_pk_fma_f32 v[40:41], v[54:55], v[38:39], v[40:41] op_sel:[1,1,0] op_sel_hi:[1,0,1] neg_lo:[0,1,0]
    ds_write_b64 v5, v[40:41] offset:4928
    s_waitcnt lgkmcnt(0)
    s_barrier
    s_cmp_ge_u32 s3, 4
    s_cbranch_scc1 .Lk1_b3
    v_and_b32 v6, 63, v0
    s_mul_i32 s5, s3, 704*8
    v_mul_u32_u24 v5, 88, v6
    v_add_u32 v5, s5, v5
    ds_read_b64 v[8:9], v5 offset:0
    ds_read_b64 v[10:11], v5 offset:8
    ds_read_b64 v[12:13], v5 offset:16
    ds_read_b64 v[14:15], v5 offset:24
    ds_read_b64 v[16:17], v5 offset:32
    ds_read_b64 v[18:19], v5 offset:40
    ds_read_b64 v[20:21], v5 offset:48
    ds_read_b64 v[22:23], v5 offset:56
    ds_read_b64 v[24:25], v5 offset:64
    ds_read_b64 v[26:27], v5 offset:72
    s_mul_i32 s5, s3, 648*8
    v_lshlrev_b32 v5, 3, v6
    v_add_u32 v5, s5, v5
    s_waitcnt lgkmcnt(0)
    v_pk_add_f32 v[28:29], v[12:13], v[24:25]
    v_pk_add_f32 v[30:31], v[12:13], v[24:25] neg_lo:[0,1] neg_hi:[0,1]
    v_pk_add_f32 v[32:33], v[16:17], v[20:21]
    v_pk_add_f32 v[34:35], v[16:17], v[20:21] neg_lo:[0,1] neg_hi:[0,1]
    v_pk_add_f32 v[12:13], v[28:29], v[32:33]
    v_pk_add_f32 v[16:17], v[8:9], v[12:13]
    v_pk_fma_f32 v[12:13], v[28:29], s[58:59], v[8:9]
    v_pk_fma_f32 v[12:13], v[32:33], s[60:61], v[12:13]
    v_pk_fma_f32 v[20:21], v[28:29], s[60:61], v[8:9]
    v_pk_fma_f32 v[20:21], v[32:33], s[58:59], v[20:21]
    v_pk_mul_f32 v[8:9], v[30:31], s[62:63]
    v_pk_fma_f32 v[8:9], v[34:35], s[64:65], v[8:9]
    v_pk_mul_f32 v[24:25], v[30:31], s[64:65]
    v_pk_fma_f32 v[24:25], v[34:35], s[62:63], v[24:25] neg_lo:[1,0,0] neg_hi:[1,0,0]
    v_pk_add_f32 v[28:29], v[12:13], v[8:9] op_sel:[0,1] op_sel_hi:[1,0] neg_hi:[0,1]
    v_pk_add_f32 v[30:31], v[12:13], v[8:9] op_sel:[0,1] op_sel_hi:[1,0] neg_lo:[0,1]
    v_pk_add_f32 v[32:33], v[20:21], v[24:25] op_sel:[0,1] op_sel_hi:[1,0] neg_hi:[0,1]
    v_pk_add_f32 v[34:35], v[20:21], v[24:25] op_sel:[0,1] op_sel_hi:[1,0] neg_lo:[0,1]
    v_pk_add_f32 v[8:9], v[22:23], v[14:15]
    v_pk_add_f32 v[12:13], v[22:23], v[14:15] neg_lo:[0,1] neg_hi:[0,1]
    v_pk_add_f32 v[20:21], v[26:27], v[10:11]
    v_pk_add_f32 v[24:25], v[26:27], v[10:11] neg_lo:[0,1] neg_hi:[0,1]
    v_pk_add_f32 v[10:11], v[8:9], v[20:21]
    v_pk_add_f32 v[14:15], v[18:19], v[10:11]
    v_pk_fma_f32 v[10:11], v[8:9], s[58:59], v[18:19]
    v_pk_fma_f32 v[10:11], v[20:21], s[60:61], v[10:11]
    v_pk_fma_f32 v[22:23], v[8:9], s[60:61], v[18:19]
    v_pk_fma_f32 v[22:23], v[20:21], s[58:59], v[22:23]
    v_pk_mul_f32 v[8:9], v[12:13], s[62:63]
    v_pk_fma_f32 v[8:9], v[24:25], s[64:65], v[8:9]
    v_pk_mul_f32 v[18:19], v[12:13], s[64:65]
    v_pk_fma_f32 v[18:19], v[24:25], s[62:63], v[18:19] neg_lo:[1,0,0] neg_hi:[1,0,0]
    v_pk_add_f32 v[12:13], v[10:11], v[8:9] op_sel:[0,1] op_sel_hi:[1,0] neg_hi:[0,1]
    v_pk_add_f32 v[20:21], v[10:11], v[8:9] op_sel:[0,1] op_sel_hi:[1,0] neg_lo:[0,1]
    v_pk_add_f32 v[24:25], v[22:23], v[18:19] op_sel:[0,1] op_sel_hi:[1,0] neg_hi:[0,1]
    v_pk_add_f32 v[26:27], v[22:23], v[18:19] op_sel:[0,1] op_sel_hi:[1,0] neg_lo:[0,1]
    v_pk_add_f32 v[8:9], v[16:17], v[14:15]
    v_pk_add_f32 v[10:11], v[16:17], v[14:15] neg_lo:[0,1] neg_hi:[0,1]
    v_pk_add_f32 v[14:15], v[28:29], v[12:13]
    v_pk_add_f32 v[16:17], v[28:29], v[12:13] neg_lo:[0,1] neg_hi:[0,1]
    v_pk_add_f32 v[12:13], v[32:33], v[24:25]
    v_pk_add_f32 v[18:19], v[32:33], v[24:25] neg_lo:[0,1] neg_hi:[0,1]
    v_pk_add_f32 v[22:23], v[34:35], v[26:27]
    v_pk_add_f32 v[24:25], v[34:35], v[26:27] neg_lo:[0,1] neg_hi:[0,1]
    v_pk_add_f32 v[26:27], v[30:31], v[20:21]
    v_pk_add_f32 v[28:29], v[30:31], v[20:21] neg_lo:[0,1] neg_hi:[0,1]
    ds_write_b64 v5, v[8:9] offset:22528
    ds_write_b64 v5, v[16:17] offset:23040
    ds_write_b64 v5, v[12:13] offset:23552
    ds_write_b64 v5, v[24:25] offset:24064
    ds_write_b64 v5, v[26:27] offset:24576
    ds_write_b64 v5, v[10:11] offset:25088
    ds_write_b64 v5, v[14:15] offset:25600
    ds_write_b64 v5, v[18:19] offset:26112
    ds_write_b64 v5, v[22:23] offset:26624
    ds_write_b64 v5, v[28:29] offset:27136
.Lk1_b3:
    s_waitcnt lgkmcnt(0)
    s_barrier
    s_mul_i32 s4, s2, 20544
    v_add_u32 v7, 0, v0
    v_lshrrev_b32 v8, 2, v7
    v_and_b32 v6, 3, v7
    v_mul_u32_u24 v6, 648, v6
    v_add_u32 v5, v6, v8
    v_sub_u32 v9, 640, v8
    v_cmp_eq_u32 vcc, 0, v8
    s_nop 1
    v_cndmask_b32 v9, v9, 0, vcc
    v_add_u32 v9, v9, v6
    v_lshlrev_b32 v5, 3, v5
    v_lshlrev_b32 v9, 3, v9
    ds_read_b64 v[10:11], v5 offset:22528
    ds_read_b64 v[12:13], v9 offset:22528
    v_lshlrev_b32 v7, 4, v7
    s_waitcnt lgkmcnt(0)
    v_add_f32 v16, v10, v12
    v_sub_f32 v17, v11, v13
    v_add_f32 v18, v11, v13
    v_sub_f32 v19, v12, v10
    buffer_store_dwordx4 v[16:19], v7, s[40:43], s4 offen
    v_add_u32 v7, 320, v0
    v_lshrrev_b32 v8, 2, v7
    v_and_b32 v6, 3, v7
    v_mul_u32_u24 v6, 648, v6
    v_add_u32 v5, v6, v8
    v_sub_u32 v9, 640, v8
    v_cmp_eq_u32 vcc, 0, v8
    s_nop 1
    v_cndmask_b32 v9, v9, 0, vcc
    v_add_u32 v9, v9, v6
    v_lshlrev_b32 v5, 3, v5
    v_lshlrev_b32 v9, 3, v9
    ds_read_b64 v[10:11], v5 offset:22528
    ds_read_b64 v[12:13], v9 offset:22528
    v_lshlrev_b32 v7, 4, v7
    s_waitcnt lgkmcnt(0)
    v_add_f32 v16, v10, v12
    v_sub_f32 v17, v11, v13
    v_add_f32 v18, v11, v13
    v_sub_f32 v19, v12, v10
    buffer_store_dwordx4 v[16:19], v7, s[40:43], s4 offen
    v_add_u32 v7, 640, v0
    v_lshrrev_b32 v8, 2, v7
    v_and_b32 v6, 3, v7
    v_mul_u32_u24 v6, 648, v6
    v_add_u32 v5, v6, v8
    v_sub_u32 v9, 640, v8
    v_cmp_eq_u32 vcc, 0, v8
    s_nop 1
    v_cndmask_b32 v9, v9, 0, vcc
    v_add_u32 v9, v9, v6
    v_lshlrev_b32 v5, 3, v5
    v_lshlrev_b32 v9, 3, v9
    ds_read_b64 v[10:11], v5 offset:22528
    ds_read_b64 v[12:13], v9 offset:22528
    v_lshlrev_b32 v7, 4, v7
    s_waitcnt lgkmcnt(0)
    v_add_f32 v16, v10, v12
    v_sub_f32 v17, v11, v13
    v_add_f32 v18, v11, v13
    v_sub_f32 v19, v12, v10
    buffer_store_dwordx4 v[16:19], v7, s[40:43], s4 offen
    v_add_u32 v7, 960, v0
    v_lshrrev_b32 v8, 2, v7
    v_and_b32 v6, 3, v7
    v_mul_u32_u24 v6, 648, v6
    v_add_u32 v5, v6, v8
    v_sub_u32 v9, 640, v8
    v_cmp_eq_u32 vcc, 0, v8
    s_nop 1
    v_cndmask_b32 v9, v9, 0, vcc
    v_add_u32 v9, v9, v6
    v_lshlrev_b32 v5, 3, v5
    v_lshlrev_b32 v9, 3, v9
    ds_read_b64 v[10:11], v5 offset:22528
    ds_read_b64 v[12:13], v9 offset:22528
    v_lshlrev_b32 v7, 4, v7
    s_waitcnt lgkmcnt(0)
    v_add_f32 v16, v10, v12
    v_sub_f32 v17, v11, v13
    v_add_f32 v18, v11, v13
    v_sub_f32 v19, v12, v10
    buffer_store_dwordx4 v[16:19], v7, s[40:43], s4 offen
    v_add_u32 v7, 1280, v0
    v_lshrrev_b32 v8, 2, v7
    v_and_b32 v6, 3, v7
    v_mul_u32_u24 v6, 648, v6
    v_add_u32 v5, v6, v8
    v_sub_u32 v9, 640, v8
    v_cmp_eq_u32 vcc, 0, v8
    s_nop 1
    v_cndmask_b32 v9, v9, 0, vcc
    v_add_u32 v9, v9, v6
    v_lshlrev_b32 v5, 3, v5
    v_lshlrev_b32 v9, 3, v9
    ds_read_b64 v[10:11], v5 offset:22528
    ds_read_b64 v[12:13], v9 offset:22528
    v_lshlrev_b32 v7, 4, v7
    s_waitcnt lgkmcnt(0)
    v_add_f32 v16, v10, v12
    v_sub_f32 v17, v11, v13
    v_add_f32 v18, v11, v13
    v_sub_f32 v19, v12, v10
    v_cmp_gt_u32 vcc, 20544, v7
    s_and_saveexec_b64 s[6:7], vcc
    buffer_store_dwordx4 v[16:19], v7, s[40:43], s4 offen
    s_mov_b64 exec, s[6:7]
    s_waitcnt vmcnt(0)
    s_endpgm
.Lk1_wt:
    s_mov_b32 s48, s18
    s_and_b32 s49, s19, 0xffff
    s_mov_b32 s50, 0x141000
    s_mov_b32 s51, 0x00020000
    s_mov_b32 s52, s20
    s_and_b32 s53, s21, 0xffff
    s_mov_b32 s54, 0x141000
    s_mov_b32 s55, 0x00020000
    s_sub_u32 s4, s2, 256
    s_and_b32 s5, s4, 63
    s_lshr_b32 s6, s4, 6
    s_lshl_b32 s6, s6, 6
    s_min_u32 s6, s6, 257
    s_lshr_b32 s7, s5, 3
    s_and_b32 s8, s5, 7
    s_lshl_b32 s8, s8, 3
    s_add_u32 s7, s7, s8
    s_mul_i32 s7, s7, 642
    s_lshl_b32 s8, s6, 1
    s_add_u32 s7, s7, s8
    v_and_b32 v3, 63, v0
    v_lshlrev_b32 v4, 1, v3
    v_mul_u32_u24 v5, 132, v3
    s_cmp_ge_u32 s3, 4
    s_cbranch_scc1 .Lk1_wt_bar
    s_lshl_b32 s9, s3, 1
    s_mul_i32 s9, s9, 41088
    s_add_u32 s7, s7, s9
    s_lshl_b32 s9, s3, 5
    v_add_u32 v5, s9, v5
    s_add_u32 s8, s7, 0
    buffer_load_ushort v8, v4, s[48:51], s8 offen
    buffer_load_ushort v16, v4, s[52:55], s8 offen
    s_add_u32 s8, s7, 328704
    buffer_load_ushort v9, v4, s[48:51], s8 offen
    buffer_load_ushort v17, v4, s[52:55], s8 offen
    s_add_u32 s8, s7, 657408
    buffer_load_ushort v10, v4, s[48:51], s8 offen
    buffer_load_ushort v18, v4, s[52:55], s8 offen
    s_add_u32 s8, s7, 986112
    buffer_load_ushort v11, v4, s[48:51], s8 offen
    buffer_load_ushort v19, v4, s[52:55], s8 offen
    s_add_u32 s8, s7, 41088
    buffer_load_ushort v12, v4, s[48:51], s8 offen
    buffer_load_ushort v20, v4, s[52:55], s8 offen
    s_add_u32 s8, s7, 369792
    buffer_load_ushort v13, v4, s[48:51], s8 offen
    buffer_load_ushort v21, v4, s[52:55], s8 offen
    s_add_u32 s8, s7, 698496
    buffer_load_ushort v14, v4, s[48:51], s8 offen
    buffer_load_ushort v22, v4, s[52:55], s8 offen
    s_add_u32 s8, s7, 1027200
    buffer_load_ushort v15, v4, s[48:51], s8 offen
    buffer_load_ushort v23, v4, s[52:55], s8 offen
    s_waitcnt vmcnt(0)
    v_lshl_or_b32 v8, v16, 16, v8
    ds_write_b32 v5, v8 offset:0
    v_lshl_or_b32 v9, v17, 16, v9
    ds_write_b32 v5, v9 offset:4
    v_lshl_or_b32 v10, v18, 16, v10
    ds_write_b32 v5, v10 offset:8
    v_lshl_or_b32 v11, v19, 16, v11
    ds_write_b32 v5, v11 offset:12
    v_lshl_or_b32 v12, v20, 16, v12
    ds_write_b32 v5, v12 offset:16
    v_lshl_or_b32 v13, v21, 16, v13
    ds_write_b32 v5, v13 offset:20
    v_lshl_or_b32 v14, v22, 16, v14
    ds_write_b32 v5, v14 offset:24
    v_lshl_or_b32 v15, v23, 16, v15
    ds_write_b32 v5, v15 offset:28
.Lk1_wt_bar:
    s_waitcnt lgkmcnt(0)
    s_barrier
    s_cmp_ge_u32 s3, 4
    s_cbranch_scc1 .Lk1_wt_done
    v_lshrrev_b32 v4, 3, v0
    v_and_b32 v3, 7, v0
    v_mul_u32_u24 v5, 132, v4
    v_lshl_add_u32 v5, v3, 4, v5
    v_lshlrev_b32 v4, 13, v4
    v_lshl_add_u32 v4, v3, 4, v4
    ds_read_b32 v8, v5 offset:0
    ds_read_b32 v9, v5 offset:4
    ds_read_b32 v10, v5 offset:8
    ds_read_b32 v11, v5 offset:12
    ds_read_b32 v12, v5 offset:4224
    ds_read_b32 v13, v5 offset:4228
    ds_read_b32 v14, v5 offset:4232
    ds_read_b32 v15, v5 offset:4236
    s_lshl_b32 s8, s6, 13
    s_lshl_b32 s9, s5, 7
    s_add_u32 s8, s8, s9
    s_add_u32 s8, s8, 5505024
    s_waitcnt lgkmcnt(0)
    buffer_store_dwordx4 v[8:11], v4, s[40:43], s8 offen
    s_add_u32 s8, s8, 262144
    buffer_store_dwordx4 v[12:15], v4, s[40:43], s8 offen
.Lk1_wt_done:
    s_mov_b64 exec, -1
    s_waitcnt vmcnt(0)
.Lk1_end:
    s_endpgm

.globl k2_colfft_kernel
.p2align 8
.type k2_colfft_kernel,@function
k2_colfft_kernel:
    s_cmp_ge_u32 s2, 321
    s_cbranch_scc1 .Lk2_end
    s_load_dwordx4 s[16:19], s[0:1], 32
    s_load_dwordx2 s[20:21], s[0:1], 48
    s_load_dwordx2 s[24:25], s[0:1], 80
    s_mov_b32 s56, 0x3f3504f3
    s_mov_b32 s57, 0x3f3504f3
    s_mov_b32 s58, 0x3e9e377a
    s_mov_b32 s59, 0x3e9e377a
    s_mov_b32 s60, 0xbf4f1bbd
    s_mov_b32 s61, 0xbf4f1bbd
    s_mov_b32 s62, 0x3f737871
    s_mov_b32 s63, 0x3f737871
    s_mov_b32 s64, 0x3f167918
    s_mov_b32 s65, 0x3f167918
    s_mov_b32 s68, 0x07060302
    s_mov_b32 s66, 0x3acccccd
    s_mov_b32 s67, 0x44200000
    s_waitcnt lgkmcnt(0)
    s_mov_b32 s40, s24
    s_and_b32 s41, s25, 0xffff
    s_mov_b32 s42, 0x2000000
    s_mov_b32 s43, 0x00020000
    s_cmp_ge_u32 s2, 321
    s_cbranch_scc1 .Lk2_tr
    s_and_b32 s4, s2, 7
    s_lshl_b32 s4, s4, 1
    s_lshr_b32 s5, s2, 3
    s_and_b32 s5, s5, 1
    s_add_u32 s4, s4, s5
    s_and_b32 s5, s2, 0xfffffff0
    s_add_u32 s4, s4, s5
    v_lshrrev_b32 v1, 3, v0
    v_mul_u32_u24 v1, 20544, v1
    v_and_b32 v2, 7, v0
    v_lshl_add_u32 v1, v2, 3, v1
    s_lshl_b32 s5, s4, 6
    s_add_u32 s8, s5, 0
    s_add_u32 s9, s5, 657408
    s_add_u32 s10, s5, 1314816
    s_add_u32 s11, s5, 1972224
    s_add_u32 s12, s5, 2629632
    s_add_u32 s13, s5, 3287040
    s_add_u32 s14, s5, 3944448
    s_add_u32 s15, s5, 4601856
    buffer_load_dwordx2 v[4:5], v1, s[40:43], s8 offen
    buffer_load_dwordx2 v[6:7], v1, s[40:43], s9 offen
    buffer_load_dwordx2 v[8:9], v1, s[40:43], s10 offen
    buffer_load_dwordx2 v[10:11], v1, s[40:43], s11 offen
    buffer_load_dwordx2 v[12:13], v1, s[40:43], s12 offen
    buffer_load_dwordx2 v[14:15], v1, s[40:43], s13 offen
    buffer_load_dwordx2 v[16:17], v1, s[40:43], s14 offen
    buffer_load_dwordx2 v[18:19], v1, s[40:43], s15 offen
    s_lshl_b32 s5, s4, 13
    s_add_u32 s5, s5, 5505024
    v_lshlrev_b32 v2, 5, v0
    buffer_load_dwordx4 v[20:23], v2, s[40:43], s5 offen
    buffer_load_dwordx4 v[24:27], v2, s[40:43], s5 offen offset:16
    v_cvt_f32_u32 v28, v0
    v_mul_f32 v28, 0xba000000, v28
    v_mul_f32 v31, 1.0, v28
    v_mul_f32 v33, 2.0, v28
    v_mul_f32 v35, 0x40400000, v28
    v_mul_f32 v37, 4.0, v28
    v_mul_f32 v39, 0x40a00000, v28
    v_mul_f32 v41, 0x40c00000, v28
    v_mul_f32 v43, 0x40e00000, v28
    v_cos_f32 v30, v31
    v_sin_f32 v31, v31
    v_cos_f32 v32, v33
    v_sin_f32 v33, v33
    v_cos_f32 v34, v35
    v_sin_f32 v35, v35
    v_cos_f32 v36, v37
    v_sin_f32 v37, v37
    v_cos_f32 v38, v39
    v_sin_f32 v39, v39
    v_cos_f32 v40, v41
    v_sin_f32 v41, v41
    v_cos_f32 v42, v43
    v_sin_f32 v43, v43
    v_and_b32 v2, 31, v0
    v_cvt_f32_u32 v44, v2
    v_mul_f32 v44, 0xbb800000, v44
    v_mul_f32 v47, 1.0, v44
    v_mul_f32 v49, 2.0, v44
    v_mul_f32 v51, 0x40400000, v44
    v_mul_f32 v53, 4.0, v44
    v_mul_f32 v55, 0x40a00000, v44
    v_mul_f32 v57, 0x40c00000, v44
    v_mul_f32 v59, 0x40e00000, v44
    v_cos_f32 v46, v47
    v_sin_f32 v47, v47
    v_cos_f32 v48, v49
    v_sin_f32 v49, v49
    v_cos_f32 v50, v51
    v_sin_f32 v51, v51
    v_cos_f32 v52, v53
    v_sin_f32 v53, v53
    v_cos_f32 v54, v55
    v_sin_f32 v55, v55
    v_cos_f32 v56, v57
    v_sin_f32 v57, v57
    v_cos_f32 v58, v59
    v_sin_f32 v59, v59
    v_and_b32 v2, 3, v0
    v_cvt_f32_u32 v60, v2
    v_mul_f32 v60, 0xbd000000, v60
    v_mul_f32 v63, 1.0, v60
    v_mul_f32 v65, 2.0, v60
    v_mul_f32 v67, 0x40400000, v60
    v_mul_f32 v69, 4.0, v60
    v_mul_f32 v71, 0x40a00000, v60
    v_mul_f32 v73, 0x40c00000, v60
    v_mul_f32 v75, 0x40e00000, v60
    v_cos_f32 v62, v63
    v_sin_f32 v63, v63
    v_cos_f32 v64, v65
    v_sin_f32 v65, v65
    v_cos_f32 v66, v67
    v_sin_f32 v67, v67
    v_cos_f32 v68, v69
    v_sin_f32 v69, v69
    v_cos_f32 v70, v71
    v_sin_f32 v71, v71
    v_cos_f32 v72, v73
    v_sin_f32 v73, v73
    v_cos_f32 v74, v75
    v_sin_f32 v75, v75
    v_lshlrev_b32 v76, 3, v0
    v_lshrrev_b32 v2, 5, v0
    v_lshlrev_b32 v77, 8, v2
    v_and_b32 v3, 31, v0
    v_add_u32 v77, v77, v3
    v_lshlrev_b32 v77, 3, v77
    v_mul_u32_u24 v78, 288, v2
    v_add_u32 v78, v78, v3
    v_lshlrev_b32 v78, 3, v78
    v_lshrrev_b32 v2, 2, v0
    v_mul_u32_u24 v79, 36, v2
    v_and_b32 v3, 3, v0
    v_lshlrev_b32 v81, 3, v3
    v_add_u32 v81, v81, v79
    v_lshlrev_b32 v81, 3, v81
    v_add_u32 v79, v79, v3
    v_lshlrev_b32 v79, 3, v79
    s_waitcnt vmcnt(2)
    v_pk_add_f32 v[82:83], v[4:5], v[12:13]
    v_pk_add_f32 v[84:85], v[4:5], v[12:13] neg_lo:[0,1] neg_hi:[0,1]
    v_pk_add_f32 v[4:5], v[6:7], v[14:15]
    v_pk_add_f32 v[12:13], v[6:7], v[14:15] neg_lo:[0,1] neg_hi:[0,1]
    v_pk_add_f32 v[6:7], v[8:9], v[16:17]
    v_pk_add_f32 v[14:15], v[8:9], v[16:17] neg_lo:[0,1] neg_hi:[0,1]
    v_pk_add_f32 v[8:9], v[10:11], v[18:19]
    v_pk_add_f32 v[16:17], v[10:11], v[18:19] neg_lo:[0,1] neg_hi:[0,1]
    v_pk_add_f32 v[10:11], v[12:13], v[12:13] op_sel:[0,1] op_sel_hi:[1,0] neg_hi:[0,1]
    v_pk_mul_f32 v[10:11], v[10:11], s[56:57]
    v_pk_add_f32 v[12:13], v[16:17], v[16:17] op_sel:[0,1] op_sel_hi:[1,0] neg_lo:[1,0] neg_hi:[1,1]
    v_pk_mul_f32 v[12:13], v[12:13], s[56:57]
    v_pk_add_f32 v[16:17], v[82:83], v[6:7]
    v_pk_add_f32 v[18:19], v[82:83], v[6:7] neg_lo:[0,1] neg_hi:[0,1]
    v_pk_add_f32 v[6:7], v[4:5], v[8:9]
    v_pk_add_f32 v[82:83], v[4:5], v[8:9] neg_lo:[0,1] neg_hi:[0,1]
    v_pk_add_f32 v[4:5], v[16:17], v[6:7]
    v_pk_add_f32 v[8:9], v[16:17], v[6:7] neg_lo:[0,1] neg_hi:[0,1]
    v_pk_add_f32 v[6:7], v[18:19], v[82:83] op_sel:[0,1] op_sel_hi:[1,0] neg_hi:[0,1]
    v_pk_add_f32 v[16:17], v[18:19], v[82:83] op_sel:[0,1] op_sel_hi:[1,0] neg_lo:[0,1]
    v_pk_add_f32 v[18:19], v[84:85], v[14:15] op_sel:[0,1] op_sel_hi:[1,0] neg_hi:[0,1]
    v_pk_add_f32 v[82:83], v[84:85], v[14:15] op_sel:[0,1] op_sel_hi:[1,0] neg_lo:[0,1]
    v_pk_add_f32 v[14:15], v[10:11], v[12:13]
    v_pk_add_f32 v[84:85], v[10:11], v[12:13] neg_lo:[0,1] neg_hi:[0,1]
    v_pk_add_f32 v[10:11], v[18:19], v[14:15]
    v_pk_add_f32 v[12:13], v[18:19], v[14:15] neg_lo:[0,1] neg_hi:[0,1]
    v_pk_add_f32 v[14:15], v[82:83], v[84:85] op_sel:[0,1] op_sel_hi:[1,0] neg_hi:[0,1]
    v_pk_add_f32 v[18:19], v[82:83], v[84:85] op_sel:[0,1] op_sel_hi:[1,0] neg_lo:[0,1]
    ds_write_b64 v76, v[4:5] offset:0
    v_pk_mul_f32 v[4:5], v[10:11], v[30:31] op_sel_hi:[0,1]
    v_pk_fma_f32 v[4:5], v[10:11], v[30:31], v[4:5] op_sel:[1,1,0] op_sel_hi:[1,0,1] neg_lo:[0,1,0]
    ds_write_b64 v76, v[4:5] offset:2048
    v_pk_mul_f32 v[4:5], v[6:7], v[32:33] op_sel_hi:[0,1]
    v_pk_fma_f32 v[4:5], v[6:7], v[32:33], v[4:5] op_sel:[1,1,0] op_sel_hi:[1,0,1] neg_lo:[0,1,0]
    ds_write_b64 v76, v[4:5] offset:4096
    v_pk_mul_f32 v[4:5], v[14:15], v[34:35] op_sel_hi:[0,1]
    v_pk_fma_f32 v[4:5], v[14:15], v[34:35], v[4:5] op_sel:[1,1,0] op_sel_hi:[1,0,1] neg_lo:[0,1,0]
    ds_write_b64 v76, v[4:5] offset:6144
    v_pk_mul_f32 v[4:5], v[8:9], v[36:37] op_sel_hi:[0,1]
    v_pk_fma_f32 v[4:5], v[8:9], v[36:37], v[4:5] op_sel:[1,1,0] op_sel_hi:[1,0,1] neg_lo:[0,1,0]
    ds_write_b64 v76, v[4:5] offset:8192
    v_pk_mul_f32 v[4:5], v[12:13], v[38:39] op_sel_hi:[0,1]
    v_pk_fma_f32 v[4:5], v[12:13], v[38:39], v[4:5] op_sel:[1,1,0] op_sel_hi:[1,0,1] neg_lo:[0,1,0]
    ds_write_b64 v76, v[4:5] offset:10240
    v_pk_mul_f32 v[4:5], v[16:17], v[40:41] op_sel_hi:[0,1]
    v_pk_fma_f32 v[4:5], v[16:17], v[40:41], v[4:5] op_sel:[1,1,0] op_sel_hi:[1,0,1] neg_lo:[0,1,0]
    ds_write_b64 v76, v[4:5] offset:12288
    v_pk_mul_f32 v[4:5], v[18:19], v[42:43] op_sel_hi:[0,1]
    v_pk_fma_f32 v[4:5], v[18:19], v[42:43], v[4:5] op_sel:[1,1,0] op_sel_hi:[1,0,1] neg_lo:[0,1,0]
    ds_write_b64 v76, v[4:5] offset:14336
    s_waitcnt lgkmcnt(0)
    s_barrier
    s_cmp_ge_u32 s2, 160
    s_cselect_b32 s36, s20, s16
    s_cselect_b32 s37, s21, s17
    s_cselect_b32 s5, 160, 0
    s_and_b32 s37, s37, 0xffff
    s_mov_b32 s38, 1966080
    s_mov_b32 s39, 0x00020000
    s_sub_u32 s5, s2, s5
    s_mul_i32 s5, s5, 12288
    v_lshlrev_b32 v8, 4, v0
    buffer_load_dwordx4 v[4:7], v8, s[36:39], s5 offen
    s_add_u32 s5, s5, 4096
    buffer_load_dwordx4 v[4:7], v8, s[36:39], s5 offen
    s_add_u32 s5, s5, 4096
    buffer_load_dwordx4 v[4:7], v8, s[36:39], s5 offen
    ds_read_b64 v[10:11], v77 offset:0
    ds_read_b64 v[12:13], v77 offset:256
    ds_read_b64 v[14:15], v77 offset:512
    ds_read_b64 v[16:17], v77 offset:768
    ds_read_b64 v[18:19], v77 offset:1024
    ds_read_b64 v[82:83], v77 offset:1280
    ds_read_b64 v[84:85], v77 offset:1536
    ds_read_b64 v[86:87], v77 offset:1792
    s_waitcnt lgkmcnt(0)
    v_pk_add_f32 v[88:89], v[10:11], v[18:19]
    v_pk_add_f32 v[90:91], v[10:11], v[18:19] neg_lo:[0,1] neg_hi:[0,1]
    v_pk_add_f32 v[10:11], v[12:13], v[82:83]
    v_pk_add_f32 v[18:19], v[12:13], v[82:83] neg_lo:[0,1] neg_hi:[0,1]
    v_pk_add_f32 v[12:13], v[14:15], v[84:85]
    v_pk_add_f32 v[82:83], v[14:15], v[84:85] neg_lo:[0,1] neg_hi:[0,1]
    v_pk_add_f32 v[14:15], v[16:17], v[86:87]
    v_pk_add_f32 v[84:85], v[16:17], v[86:87] neg_lo:[0,1] neg_hi:[0,1]
    v_pk_add_f32 v[16:17], v[18:19], v[18:19] op_sel:[0,1] op_sel_hi:[1,0] neg_hi:[0,1]
    v_pk_mul_f32 v[16:17], v[16:17], s[56:57]
    v_pk_add_f32 v[18:19], v[84:85], v[84:85] op_sel:[0,1] op_sel_hi:[1,0] neg_lo:[1,0] neg_hi:[1,1]
    v_pk_mul_f32 v[18:19], v[18:19], s[56:57]
    v_pk_add_f32 v[84:85], v[88:89], v[12:13]
    v_pk_add_f32 v[86:87], v[88:89], v[12:13] neg_lo:[0,1] neg_hi:[0,1]
    v_pk_add_f32 v[12:13], v[10:11], v[14:15]
    v_pk_add_f32 v[88:89], v[10:11], v[14:15] neg_lo:[0,1] neg_hi:[0,1]
    v_pk_add_f32 v[10:11], v[84:85], v[12:13]
    v_pk_add_f32 v[14:15], v[84:85], v[12:13] neg_lo:[0,1] neg_hi:[0,1]
    v_pk_add_f32 v[12:13], v[86:87], v[88:89] op_sel:[0,1] op_sel_hi:[1,0] neg_hi:[0,1]
    v_pk_add_f32 v[84:85], v[86:87], v[88:89] op_sel:[0,1] op_sel_hi:[1,0] neg_lo:[0,1]
    v_pk_add_f32 v[86:87], v[90:91], v[82:83] op_sel:[0,1] op_sel_hi:[1,0] neg_hi:[0,1]
    v_pk_add_f32 v[88:89], v[90:91], v[82:83] op_sel:[0,1] op_sel_hi:[1,0] neg_lo:[0,1]
    v_pk_add_f32 v[82:83], v[16:17], v[18:19]
    v_pk_add_f32 v[90:91], v[16:17], v[18:19] neg_lo:[0,1] neg_hi:[0,1]
    v_pk_add_f32 v[16:17], v[86:87], v[82:83]
    v_pk_add_f32 v[18:19], v[86:87], v[82:83] neg_lo:[0,1] neg_hi:[0,1]
    v_pk_add_f32 v[82:83], v[88:89], v[90:91] op_sel:[0,1] op_sel_hi:[1,0] neg_hi:[0,1]
    v_pk_add_f32 v[86:87], v[88:89], v[90:91] op_sel:[0,1] op_sel_hi:[1,0] neg_lo:[0,1]
    ds_write_b64 v78, v[10:11] offset:18432
    v_pk_mul_f32 v[10:11], v[16:17], v[46:47] op_sel_hi:[0,1]
    v_pk_fma_f32 v[10:11], v[16:17], v[46:47], v[10:11] op_sel:[1,1,0] op_sel_hi:[1,0,1] neg_lo:[0,1,0]
    ds_write_b64 v78, v[10:11] offset:18720
    v_pk_mul_f32 v[10:11], v[12:13], v[48:49] op_sel_hi:[0,1]
    v_pk_fma_f32 v[10:11], v[12:13], v[48:49], v[10:11] op_sel:[1,1,0] op_sel_hi:[1,0,1] neg_lo:[0,1,0]
    ds_write_b64 v78, v[10:11] offset:19008
    v_pk_mul_f32 v[10:11], v[82:83], v[50:51] op_sel_hi:[0,1]
    v_pk_fma_f32 v[10:11], v[82:83], v[50:51], v[10:11] op_sel:[1,1,0] op_sel_hi:[1,0,1] neg_lo:[0,1,0]
    ds_write_b64 v78, v[10:11] offset:19296
    v_pk_mul_f32 v[10:11], v[14:15], v[52:53] op_sel_hi:[0,1]
    v_pk_fma_f32 v[10:11], v[14:15], v[52:53], v[10:11] op_sel:[1,1,0] op_sel_hi:[1,0,1] neg_lo:[0,1,0]
    ds_write_b64 v78, v[10:11] offset:19584
    v_pk_mul_f32 v[10:11], v[18:19], v[54:55] op_sel_hi:[0,1]
    v_pk_fma_f32 v[10:11], v[18:19], v[54:55], v[10:11] op_sel:[1,1,0] op_sel_hi:[1,0,1] neg_lo:[0,1,0]
    ds_write_b64 v78, v[10:11] offset:19872
    v_pk_mul_f32 v[10:11], v[84:85], v[56:57] op_sel_hi:[0,1]
    v_pk_fma_f32 v[10:11], v[84:85], v[56:57], v[10:11] op_sel:[1,1,0] op_sel_hi:[1,0,1] neg_lo:[0,1,0]
    ds_write_b64 v78, v[10:11] offset:20160
    v_pk_mul_f32 v[10:11], v[86:87], v[58:59] op_sel_hi:[0,1]
    v_pk_fma_f32 v[10:11], v[86:87], v[58:59], v[10:11] op_sel:[1,1,0] op_sel_hi:[1,0,1] neg_lo:[0,1,0]
    ds_write_b64 v78, v[10:11] offset:20448
    s_waitcnt lgkmcnt(0)
    s_barrier
    ds_read_b64 v[10:11], v79 offset:18432
    ds_read_b64 v[12:13], v79 offset:18464
    ds_read_b64 v[14:15], v79 offset:18496
    ds_read_b64 v[16:17], v79 offset:18528
    ds_read_b64 v[18:19], v79 offset:18560
    ds_read_b64 v[82:83], v79 offset:18592
    ds_read_b64 v[84:85], v79 offset:18624
    ds_read_b64 v[86:87], v79 offset:18656
    s_waitcnt lgkmcnt(0)
    v_pk_add_f32 v[88:89], v[10:11], v[18:19]
    v_pk_add_f32 v[90:91], v[10:11], v[18:19] neg_lo:[0,1] neg_hi:[0,1]
    v_pk_add_f32 v[10:11], v[12:13], v[82:83]
    v_pk_add_f32 v[18:19], v[12:13], v[82:83] neg_lo:[0,1] neg_hi:[0,1]
    v_pk_add_f32 v[12:13], v[14:15], v[84:85]
    v_pk_add_f32 v[82:83], v[14:15], v[84:85] neg_lo:[0,1] neg_hi:[0,1]
    v_pk_add_f32 v[14:15], v[16:17], v[86:87]
    v_pk_add_f32 v[84:85], v[16:17], v[86:87] neg_lo:[0,1] neg_hi:[0,1]
    v_pk_add_f32 v[16:17], v[18:19], v[18:19] op_sel:[0,1] op_sel_hi:[1,0] neg_hi:[0,1]
    v_pk_mul_f32 v[16:17], v[16:17], s[56:57]
    v_pk_add_f32 v[18:19], v[84:85], v[84:85] op_sel:[0,1] op_sel_hi:[1,0] neg_lo:[1,0] neg_hi:[1,1]
    v_pk_mul_f32 v[18:19], v[18:19], s[56:57]
    v_pk_add_f32 v[84:85], v[88:89], v[12:13]
    v_pk_add_f32 v[86:87], v[88:89], v[12:13] neg_lo:[0,1] neg_hi:[0,1]
    v_pk_add_f32 v[12:13], v[10:11], v[14:15]
    v_pk_add_f32 v[88:89], v[10:11], v[14:15] neg_lo:[0,1] neg_hi:[0,1]
    v_pk_add_f32 v[10:11], v[84:85], v[12:13]
    v_pk_add_f32 v[14:15], v[84:85], v[12:13] neg_lo:[0,1] neg_hi:[0,1]
    v_pk_add_f32 v[12:13], v[86:87], v[88:89] op_sel:[0,1] op_sel_hi:[1,0] neg_hi:[0,1]
    v_pk_add_f32 v[84:85], v[86:87], v[88:89] op_sel:[0,1] op_sel_hi:[1,0] neg_lo:[0,1]
    v_pk_add_f32 v[86:87], v[90:91], v[82:83] op_sel:[0,1] op_sel_hi:[1,0] neg_hi:[0,1]
    v_pk_add_f32 v[88:89], v[90:91], v[82:83] op_sel:[0,1] op_sel_hi:[1,0] neg_lo:[0,1]
    v_pk_add_f32 v[82:83], v[16:17], v[18:19]
    v_pk_add_f32 v[90:91], v[16:17], v[18:19] neg_lo:[0,1] neg_hi:[0,1]
    v_pk_add_f32 v[16:17], v[86:87], v[82:83]
    v_pk_add_f32 v[18:19], v[86:87], v[82:83] neg_lo:[0,1] neg_hi:[0,1]
    v_pk_add_f32 v[82:83], v[88:89], v[90:91] op_sel:[0,1] op_sel_hi:[1,0] neg_hi:[0,1]
    v_pk_add_f32 v[86:87], v[88:89], v[90:91] op_sel:[0,1] op_sel_hi:[1,0] neg_lo:[0,1]
    ds_write_b64 v79, v[10:11] offset:0
    v_pk_mul_f32 v[10:11], v[16:17], v[62:63] op_sel_hi:[0,1]
    v_pk_fma_f32 v[10:11], v[16:17], v[62:63], v[10:11] op_sel:[1,1,0] op_sel_hi:[1,0,1] neg_lo:[0,1,0]
    ds_write_b64 v79, v[10:11] offset:32
    v_pk_mul_f32 v[10:11], v[12:13], v[64:65] op_sel_hi:[0,1]
    v_pk_fma_f32 v[10:11], v[12:13], v[64:65], v[10:11] op_sel:[1,1,0] op_sel_hi:[1,0,1] neg_lo:[0,1,0]
    ds_write_b64 v79, v[10:11] offset:64
    v_pk_mul_f32 v[10:11], v[82:83], v[66:67] op_sel_hi:[0,1]
    v_pk_fma_f32 v[10:11], v[82:83], v[66:67], v[10:11] op_sel:[1,1,0] op_sel_hi:[1,0,1] neg_lo:[0,1,0]
    ds_write_b64 v79, v[10:11] offset:96
    v_pk_mul_f32 v[10:11], v[14:15], v[68:69] op_sel_hi:[0,1]
    v_pk_fma_f32 v[10:11], v[14:15], v[68:69], v[10:11] op_sel:[1,1,0] op_sel_hi:[1,0,1] neg_lo:[0,1,0]
    ds_write_b64 v79, v[10:11] offset:128
    v_pk_mul_f32 v[10:11], v[18:19], v[70:71] op_sel_hi:[0,1]
    v_pk_fma_f32 v[10:11], v[18:19], v[70:71], v[10:11] op_sel:[1,1,0] op_sel_hi:[1,0,1] neg_lo:[0,1,0]
    ds_write_b64 v79, v[10:11] offset:160
    v_pk_mul_f32 v[10:11], v[84:85], v[72:73] op_sel_hi:[0,1]
    v_pk_fma_f32 v[10:11], v[84:85], v[72:73], v[10:11] op_sel:[1,1,0] op_sel_hi:[1,0,1] neg_lo:[0,1,0]
    ds_write_b64 v79, v[10:11] offset:192
    v_pk_mul_f32 v[10:11], v[86:87], v[74:75] op_sel_hi:[0,1]
    v_pk_fma_f32 v[10:11], v[86:87], v[74:75], v[10:11] op_sel:[1,1,0] op_sel_hi:[1,0,1] neg_lo:[0,1,0]
    ds_write_b64 v79, v[10:11] offset:224
    s_waitcnt lgkmcnt(0)
    s_barrier
    ds_read_b64 v[10:11], v81 offset:0
    ds_read_b64 v[12:13], v81 offset:8
    ds_read_b64 v[14:15], v81 offset:16
    ds_read_b64 v[16:17], v81 offset:24
    ds_read_b64 v[18:19], v81 offset:32
    ds_read_b64 v[82:83], v81 offset:40
    ds_read_b64 v[84:85], v81 offset:48
    ds_read_b64 v[86:87], v81 offset:56
    s_mov_b32 s69, 0x34cccccd
    s_waitcnt vmcnt(3) lgkmcnt(0)
    v_pk_add_f32 v[88:89], v[10:11], v[14:15]
    v_pk_add_f32 v[90:91], v[10:11], v[14:15] neg_lo:[0,1] neg_hi:[0,1]
    v_pk_add_f32 v[10:11], v[12:13], v[16:17]
    v_pk_add_f32 v[14:15], v[12:13], v[16:17] neg_lo:[0,1] neg_hi:[0,1]
    v_pk_add_f32 v[12:13], v[88:89], v[10:11]
    v_pk_add_f32 v[16:17], v[88:89], v[10:11] neg_lo:[0,1] neg_hi:[0,1]
    v_pk_add_f32 v[10:11], v[90:91], v[14:15] op_sel:[0,1] op_sel_hi:[1,0] neg_hi:[0,1]
    v_pk_add_f32 v[88:89], v[90:91], v[14:15] op_sel:[0,1] op_sel_hi:[1,0] neg_lo:[0,1]
    v_pk_add_f32 v[14:15], v[18:19], v[84:85]
    v_pk_add_f32 v[90:91], v[18:19], v[84:85] neg_lo:[0,1] neg_hi:[0,1]
    v_pk_add_f32 v[18:19], v[82:83], v[86:87]
    v_pk_add_f32 v[84:85], v[82:83], v[86:87] neg_lo:[0,1] neg_hi:[0,1]
    v_pk_add_f32 v[82:83], v[14:15], v[18:19]
    v_pk_add_f32 v[86:87], v[14:15], v[18:19] neg_lo:[0,1] neg_hi:[0,1]
    v_pk_add_f32 v[14:15], v[90:91], v[84:85] op_sel:[0,1] op_sel_hi:[1,0] neg_hi:[0,1]
    v_pk_add_f32 v[18:19], v[90:91], v[84:85] op_sel:[0,1] op_sel_hi:[1,0] neg_lo:[0,1]
    v_lshlrev_b32 v84, 16, v20
    v_and_b32 v85, 0xffff0000, v20
    v_mul_f32 v84, s69, v84
    v_mul_f32 v85, s69, v85
    v_pk_mul_f32 v[90:91], v[12:13], v[84:85] op_sel_hi:[0,1]
    v_pk_fma_f32 v[90:91], v[12:13], v[84:85], v[90:91] op_sel:[1,1,0] op_sel_hi:[1,0,1] neg_lo:[0,1,0]
    v_lshlrev_b32 v84, 16, v21
    v_and_b32 v85, 0xffff0000, v21
    v_mul_f32 v84, s69, v84
    v_mul_f32 v85, s69, v85
    v_pk_mul_f32 v[12:13], v[10:11], v[84:85] op_sel_hi:[0,1]
    v_pk_fma_f32 v[12:13], v[10:11], v[84:85], v[12:13] op_sel:[1,1,0] op_sel_hi:[1,0,1] neg_lo:[0,1,0]
    v_lshlrev_b32 v84, 16, v22
    v_and_b32 v85, 0xffff0000, v22
    v_mul_f32 v84, s69, v84
    v_mul_f32 v85, s69, v85
    v_pk_mul_f32 v[10:11], v[16:17], v[84:85] op_sel_hi:[0,1]
    v_pk_fma_f32 v[10:11], v[16:17], v[84:85], v[10:11] op_sel:[1,1,0] op_sel_hi:[1,0,1] neg_lo:[0,1,0]
    v_lshlrev_b32 v84, 16, v23
    v_and_b32 v85, 0xffff0000, v23
    v_mul_f32 v84, s69, v84
    v_mul_f32 v85, s69, v85
    v_pk_mul_f32 v[16:17], v[88:89], v[84:85] op_sel_hi:[0,1]
    v_pk_fma_f32 v[16:17], v[88:89], v[84:85], v[16:17] op_sel:[1,1,0] op_sel_hi:[1,0,1] neg_lo:[0,1,0]
    v_lshlrev_b32 v84, 16, v24
    v_and_b32 v85, 0xffff0000, v24
    v_mul_f32 v84, s69, v84
    v_mul_f32 v85, s69, v85
    v_pk_mul_f32 v[88:89], v[82:83], v[84:85] op_sel_hi:[0,1]
    v_pk_fma_f32 v[88:89], v[82:83], v[84:85], v[88:89] op_sel:[1,1,0] op_sel_hi:[1,0,1] neg_lo:[0,1,0]
    v_lshlrev_b32 v84, 16, v25
    v_and_b32 v85, 0xffff0000, v25
    v_mul_f32 v84, s69, v84
    v_mul_f32 v85, s69, v85
    v_pk_mul_f32 v[82:83], v[14:15], v[84:85] op_sel_hi:[0,1]
    v_pk_fma_f32 v[82:83], v[14:15], v[84:85], v[82:83] op_sel:[1,1,0] op_sel_hi:[1,0,1] neg_lo:[0,1,0]
    v_lshlrev_b32 v84, 16, v26
    v_and_b32 v85, 0xffff0000, v26
    v_mul_f32 v84, s69, v84
    v_mul_f32 v85, s69, v85
    v_pk_mul_f32 v[14:15], v[86:87], v[84:85] op_sel_hi:[0,1]
    v_pk_fma_f32 v[14:15], v[86:87], v[84:85], v[14:15] op_sel:[1,1,0] op_sel_hi:[1,0,1] neg_lo:[0,1,0]
    v_lshlrev_b32 v84, 16, v27
    v_and_b32 v85, 0xffff0000, v27
    v_mul_f32 v84, s69, v84
    v_mul_f32 v85, s69, v85
    v_pk_mul_f32 v[86:87], v[18:19], v[84:85] op_sel_hi:[0,1]
    v_pk_fma_f32 v[86:87], v[18:19], v[84:85], v[86:87] op_sel:[1,1,0] op_sel_hi:[1,0,1] neg_lo:[0,1,0]
    v_pk_add_f32 v[8:9], v[90:91], v[10:11]
    v_pk_add_f32 v[18:19], v[90:91], v[10:11] neg_lo:[0,1] neg_hi:[0,1]
    v_pk_add_f32 v[10:11], v[12:13], v[16:17]
    v_pk_add_f32 v[20:21], v[12:13], v[16:17] neg_lo:[0,1] neg_hi:[0,1]
    v_pk_add_f32 v[12:13], v[8:9], v[10:11]
    v_pk_add_f32 v[16:17], v[8:9], v[10:11] neg_lo:[0,1] neg_hi:[0,1]
    v_pk_add_f32 v[8:9], v[18:19], v[20:21] op_sel:[0,1] op_sel_hi:[1,0] neg_lo:[0,1]
    v_pk_add_f32 v[10:11], v[18:19], v[20:21] op_sel:[0,1] op_sel_hi:[1,0] neg_hi:[0,1]
    v_pk_add_f32 v[18:19], v[88:89], v[14:15]
    v_pk_add_f32 v[20:21], v[88:89], v[14:15] neg_lo:[0,1] neg_hi:[0,1]
    v_pk_add_f32 v[14:15], v[82:83], v[86:87]
    v_pk_add_f32 v[22:23], v[82:83], v[86:87] neg_lo:[0,1] neg_hi:[0,1]
    v_pk_add_f32 v[24:25], v[18:19], v[14:15]
    v_pk_add_f32 v[26:27], v[18:19], v[14:15] neg_lo:[0,1] neg_hi:[0,1]
    v_pk_add_f32 v[14:15], v[20:21], v[22:23] op_sel:[0,1] op_sel_hi:[1,0] neg_lo:[0,1]
    v_pk_add_f32 v[18:19], v[20:21], v[22:23] op_sel:[0,1] op_sel_hi:[1,0] neg_hi:[0,1]
    ds_write_b64 v81, v[12:13] offset:18432
    ds_write_b64 v81, v[8:9] offset:18440
    ds_write_b64 v81, v[16:17] offset:18448
    ds_write_b64 v81, v[10:11] offset:18456
    ds_write_b64 v81, v[24:25] offset:18464
    ds_write_b64 v81, v[14:15] offset:18472
    ds_write_b64 v81, v[26:27] offset:18480
    ds_write_b64 v81, v[18:19] offset:18488
    s_waitcnt lgkmcnt(0)
    s_barrier
    ds_read_b64 v[8:9], v79 offset:18432
    ds_read_b64 v[10:11], v79 offset:18464
    ds_read_b64 v[12:13], v79 offset:18496
    ds_read_b64 v[14:15], v79 offset:18528
    ds_read_b64 v[16:17], v79 offset:18560
    ds_read_b64 v[18:19], v79 offset:18592
    ds_read_b64 v[20:21], v79 offset:18624
    ds_read_b64 v[22:23], v79 offset:18656
    s_waitcnt lgkmcnt(0)
    v_pk_mul_f32 v[24:25], v[10:11], v[62:63] op_sel_hi:[0,1] neg_hi:[0,1]
    v_pk_fma_f32 v[24:25], v[10:11], v[62:63], v[24:25] op_sel:[1,1,0] op_sel_hi:[1,0,1]
    v_pk_mul_f32 v[10:11], v[12:13], v[64:65] op_sel_hi:[0,1] neg_hi:[0,1]
    v_pk_fma_f32 v[10:11], v[12:13], v[64:65], v[10:11] op_sel:[1,1,0] op_sel_hi:[1,0,1]
    v_pk_mul_f32 v[12:13], v[14:15], v[66:67] op_sel_hi:[0,1] neg_hi:[0,1]
    v_pk_fma_f32 v[12:13], v[14:15], v[66:67], v[12:13] op_sel:[1,1,0] op_sel_hi:[1,0,1]
    v_pk_mul_f32 v[14:15], v[16:17], v[68:69] op_sel_hi:[0,1] neg_hi:[0,1]
    v_pk_fma_f32 v[14:15], v[16:17], v[68:69], v[14:15] op_sel:[1,1,0] op_sel_hi:[1,0,1]
    v_pk_mul_f32 v[16:17], v[18:19], v[70:71] op_sel_hi:[0,1] neg_hi:[0,1]
    v_pk_fma_f32 v[16:17], v[18:19], v[70:71], v[16:17] op_sel:[1,1,0] op_sel_hi:[1,0,1]
    v_pk_mul_f32 v[18:19], v[20:21], v[72:73] op_sel_hi:[0,1] neg_hi:[0,1]
    v_pk_fma_f32 v[18:19], v[20:21], v[72:73], v[18:19] op_sel:[1,1,0] op_sel_hi:[1,0,1]
    v_pk_mul_f32 v[20:21], v[22:23], v[74:75] op_sel_hi:[0,1] neg_hi:[0,1]
    v_pk_fma_f32 v[20:21], v[22:23], v[74:75], v[20:21] op_sel:[1,1,0] op_sel_hi:[1,0,1]
    v_pk_add_f32 v[22:23], v[8:9], v[14:15]
    v_pk_add_f32 v[26:27], v[8:9], v[14:15] neg_lo:[0,1] neg_hi:[0,1]
    v_pk_add_f32 v[8:9], v[24:25], v[16:17]
    v_pk_add_f32 v[14:15], v[24:25], v[16:17] neg_lo:[0,1] neg_hi:[0,1]
    v_pk_add_f32 v[16:17], v[10:11], v[18:19]
    v_pk_add_f32 v[24:25], v[10:11], v[18:19] neg_lo:[0,1] neg_hi:[0,1]
    v_pk_add_f32 v[10:11], v[12:13], v[20:21]
    v_pk_add_f32 v[18:19], v[12:13], v[20:21] neg_lo:[0,1] neg_hi:[0,1]
    v_pk_add_f32 v[12:13], v[14:15], v[14:15] op_sel:[0,1] op_sel_hi:[1,0] neg_lo:[0,1]
    v_pk_mul_f32 v[12:13], v[12:13], s[56:57]
    v_pk_add_f32 v[14:15], v[18:19], v[18:19] op_sel:[0,1] op_sel_hi:[1,0] neg_lo:[1,1] neg_hi:[1,0]
    v_pk_mul_f32 v[14:15], v[14:15], s[56:57]
    v_pk_add_f32 v[18:19], v[22:23], v[16:17]
    v_pk_add_f32 v[20:21], v[22:23], v[16:17] neg_lo:[0,1] neg_hi:[0,1]
    v_pk_add_f32 v[16:17], v[8:9], v[10:11]
    v_pk_add_f32 v[22:23], v[8:9], v[10:11] neg_lo:[0,1] neg_hi:[0,1]
    v_pk_add_f32 v[8:9], v[18:19], v[16:17]
    v_pk_add_f32 v[10:11], v[18:19], v[16:17] neg_lo:[0,1] neg_hi:[0,1]
    v_pk_add_f32 v[16:17], v[20:21], v[22:23] op_sel:[0,1] op_sel_hi:[1,0] neg_lo:[0,1]
    v_pk_add_f32 v[18:19], v[20:21], v[22:23] op_sel:[0,1] op_sel_hi:[1,0] neg_hi:[0,1]
    v_pk_add_f32 v[20:21], v[26:27], v[24:25] op_sel:[0,1] op_sel_hi:[1,0] neg_lo:[0,1]
    v_pk_add_f32 v[22:23], v[26:27], v[24:25] op_sel:[0,1] op_sel_hi:[1,0] neg_hi:[0,1]
    v_pk_add_f32 v[24:25], v[12:13], v[14:15]
    v_pk_add_f32 v[26:27], v[12:13], v[14:15] neg_lo:[0,1] neg_hi:[0,1]
    v_pk_add_f32 v[12:13], v[20:21], v[24:25]
    v_pk_add_f32 v[14:15], v[20:21], v[24:25] neg_lo:[0,1] neg_hi:[0,1]
    v_pk_add_f32 v[20:21], v[22:23], v[26:27] op_sel:[0,1] op_sel_hi:[1,0] neg_lo:[0,1]
    v_pk_add_f32 v[24:25], v[22:23], v[26:27] op_sel:[0,1] op_sel_hi:[1,0] neg_hi:[0,1]
    ds_write_b64 v79, v[8:9] offset:0
    ds_write_b64 v79, v[12:13] offset:32
    ds_write_b64 v79, v[16:17] offset:64
    ds_write_b64 v79, v[20:21] offset:96
    ds_write_b64 v79, v[10:11] offset:128
    ds_write_b64 v79, v[14:15] offset:160
    ds_write_b64 v79, v[18:19] offset:192
    ds_write_b64 v79, v[24:25] offset:224
    s_waitcnt lgkmcnt(0)
    s_barrier
    ds_read_b64 v[8:9], v78 offset:0
    ds_read_b64 v[10:11], v78 offset:288
    ds_read_b64 v[12:13], v78 offset:576
    ds_read_b64 v[14:15], v78 offset:864
    ds_read_b64 v[16:17], v78 offset:1152
    ds_read_b64 v[18:19], v78 offset:1440
    ds_read_b64 v[20:21], v78 offset:1728
    ds_read_b64 v[22:23], v78 offset:2016
    s_waitcnt lgkmcnt(0)
    v_pk_mul_f32 v[24:25], v[10:11], v[46:47] op_sel_hi:[0,1] neg_hi:[0,1]
    v_pk_fma_f32 v[24:25], v[10:11], v[46:47], v[24:25] op_sel:[1,1,0] op_sel_hi:[1,0,1]
    v_pk_mul_f32 v[10:11], v[12:13], v[48:49] op_sel_hi:[0,1] neg_hi:[0,1]
    v_pk_fma_f32 v[10:11], v[12:13], v[48:49], v[10:11] op_sel:[1,1,0] op_sel_hi:[1,0,1]
    v_pk_mul_f32 v[12:13], v[14:15], v[50:51] op_sel_hi:[0,1] neg_hi:[0,1]
    v_pk_fma_f32 v[12:13], v[14:15], v[50:51], v[12:13] op_sel:[1,1,0] op_sel_hi:[1,0,1]
    v_pk_mul_f32 v[14:15], v[16:17], v[52:53] op_sel_hi:[0,1] neg_hi:[0,1]
    v_pk_fma_f32 v[14:15], v[16:17], v[52:53], v[14:15] op_sel:[1,1,0] op_sel_hi:[1,0,1]
    v_pk_mul_f32 v[16:17], v[18:19], v[54:55] op_sel_hi:[0,1] neg_hi:[0,1]
    v_pk_fma_f32 v[16:17], v[18:19], v[54:55], v[16:17] op_sel:[1,1,0] op_sel_hi:[1,0,1]
    v_pk_mul_f32 v[18:19], v[20:21], v[56:57] op_sel_hi:[0,1] neg_hi:[0,1]
    v_pk_fma_f32 v[18:19], v[20:21], v[56:57], v[18:19] op_sel:[1,1,0] op_sel_hi:[1,0,1]
    v_pk_mul_f32 v[20:21], v[22:23], v[58:59] op_sel_hi:[0,1] neg_hi:[0,1]
    v_pk_fma_f32 v[20:21], v[22:23], v[58:59], v[20:21] op_sel:[1,1,0] op_sel_hi:[1,0,1]
    v_pk_add_f32 v[22:23], v[8:9], v[14:15]
    v_pk_add_f32 v[26:27], v[8:9], v[14:15] neg_lo:[0,1] neg_hi:[0,1]
    v_pk_add_f32 v[8:9], v[24:25], v[16:17]
    v_pk_add_f32 v[14:15], v[24:25], v[16:17] neg_lo:[0,1] neg_hi:[0,1]
    v_pk_add_f32 v[16:17], v[10:11], v[18:19]
    v_pk_add_f32 v[24:25], v[10:11], v[18:19] neg_lo:[0,1] neg_hi:[0,1]
    v_pk_add_f32 v[10:11], v[12:13], v[20:21]
    v_pk_add_f32 v[18:19], v[12:13], v[20:21] neg_lo:[0,1] neg_hi:[0,1]
    v_pk_add_f32 v[12:13], v[14:15], v[14:15] op_sel:[0,1] op_sel_hi:[1,0] neg_lo:[0,1]
    v_pk_mul_f32 v[12:13], v[12:13], s[56:57]
    v_pk_add_f32 v[14:15], v[18:19], v[18:19] op_sel:[0,1] op_sel_hi:[1,0] neg_lo:[1,1] neg_hi:[1,0]
    v_pk_mul_f32 v[14:15], v[14:15], s[56:57]
    v_pk_add_f32 v[18:19], v[22:23], v[16:17]
    v_pk_add_f32 v[20:21], v[22:23], v[16:17] neg_lo:[0,1] neg_hi:[0,1]
    v_pk_add_f32 v[16:17], v[8:9], v[10:11]
    v_pk_add_f32 v[22:23], v[8:9], v[10:11] neg_lo:[0,1] neg_hi:[0,1]
    v_pk_add_f32 v[8:9], v[18:19], v[16:17]
    v_pk_add_f32 v[10:11], v[18:19], v[16:17] neg_lo:[0,1] neg_hi:[0,1]
    v_pk_add_f32 v[16:17], v[20:21], v[22:23] op_sel:[0,1] op_sel_hi:[1,0] neg_lo:[0,1]
    v_pk_add_f32 v[18:19], v[20:21], v[22:23] op_sel:[0,1] op_sel_hi:[1,0] neg_hi:[0,1]
    v_pk_add_f32 v[20:21], v[26:27], v[24:25] op_sel:[0,1] op_sel_hi:[1,0] neg_lo:[0,1]
    v_pk_add_f32 v[22:23], v[26:27], v[24:25] op_sel:[0,1] op_sel_hi:[1,0] neg_hi:[0,1]
    v_pk_add_f32 v[24:25], v[12:13], v[14:15]
    v_pk_add_f32 v[26:27], v[12:13], v[14:15] neg_lo:[0,1] neg_hi:[0,1]
    v_pk_add_f32 v[12:13], v[20:21], v[24:25]
    v_pk_add_f32 v[14:15], v[20:21], v[24:25] neg_lo:[0,1] neg_hi:[0,1]
    v_pk_add_f32 v[20:21], v[22:23], v[26:27] op_sel:[0,1] op_sel_hi:[1,0] neg_lo:[0,1]
    v_pk_add_f32 v[24:25], v[22:23], v[26:27] op_sel:[0,1] op_sel_hi:[1,0] neg_hi:[0,1]
    ds_write_b64 v77, v[8:9] offset:18432
    ds_write_b64 v77, v[12:13] offset:18688
    ds_write_b64 v77, v[16:17] offset:18944
    ds_write_b64 v77, v[20:21] offset:19200
    ds_write_b64 v77, v[10:11] offset:19456
    ds_write_b64 v77, v[14:15] offset:19712
    ds_write_b64 v77, v[18:19] offset:19968
    ds_write_b64 v77, v[24:25] offset:20224
    s_waitcnt lgkmcnt(0)
    s_barrier
    ds_read_b64 v[8:9], v76 offset:18432
    ds_read_b64 v[10:11], v76 offset:20480
    ds_read_b64 v[12:13], v76 offset:22528
    ds_read_b64 v[14:15], v76 offset:24576
    ds_read_b64 v[16:17], v76 offset:26624
    ds_read_b64 v[18:19], v76 offset:28672
    ds_read_b64 v[20:21], v76 offset:30720
    ds_read_b64 v[22:23], v76 offset:32768
    s_waitcnt lgkmcnt(0)
    v_pk_mul_f32 v[24:25], v[10:11], v[30:31] op_sel_hi:[0,1] neg_hi:[0,1]
    v_pk_fma_f32 v[24:25], v[10:11], v[30:31], v[24:25] op_sel:[1,1,0] op_sel_hi:[1,0,1]
    v_pk_mul_f32 v[10:11], v[12:13], v[32:33] op_sel_hi:[0,1] neg_hi:[0,1]
    v_pk_fma_f32 v[10:11], v[12:13], v[32:33], v[10:11] op_sel:[1,1,0] op_sel_hi:[1,0,1]
    v_pk_mul_f32 v[12:13], v[14:15], v[34:35] op_sel_hi:[0,1] neg_hi:[0,1]
    v_pk_fma_f32 v[12:13], v[14:15], v[34:35], v[12:13] op_sel:[1,1,0] op_sel_hi:[1,0,1]
    v_pk_mul_f32 v[14:15], v[16:17], v[36:37] op_sel_hi:[0,1] neg_hi:[0,1]
    v_pk_fma_f32 v[14:15], v[16:17], v[36:37], v[14:15] op_sel:[1,1,0] op_sel_hi:[1,0,1]
    v_pk_mul_f32 v[16:17], v[18:19], v[38:39] op_sel_hi:[0,1] neg_hi:[0,1]
    v_pk_fma_f32 v[16:17], v[18:19], v[38:39], v[16:17] op_sel:[1,1,0] op_sel_hi:[1,0,1]
    v_pk_mul_f32 v[18:19], v[20:21], v[40:41] op_sel_hi:[0,1] neg_hi:[0,1]
    v_pk_fma_f32 v[18:19], v[20:21], v[40:41], v[18:19] op_sel:[1,1,0] op_sel_hi:[1,0,1]
    v_pk_mul_f32 v[20:21], v[22:23], v[42:43] op_sel_hi:[0,1] neg_hi:[0,1]
    v_pk_fma_f32 v[20:21], v[22:23], v[42:43], v[20:21] op_sel:[1,1,0] op_sel_hi:[1,0,1]
    v_pk_add_f32 v[22:23], v[8:9], v[14:15]
    v_pk_add_f32 v[26:27], v[8:9], v[14:15] neg_lo:[0,1] neg_hi:[0,1]
    v_pk_add_f32 v[8:9], v[24:25], v[16:17]
    v_pk_add_f32 v[14:15], v[24:25], v[16:17] neg_lo:[0,1] neg_hi:[0,1]
    v_pk_add_f32 v[16:17], v[10:11], v[18:19]
    v_pk_add_f32 v[24:25], v[10:11], v[18:19] neg_lo:[0,1] neg_hi:[0,1]
    v_pk_add_f32 v[10:11], v[12:13], v[20:21]
    v_pk_add_f32 v[18:19], v[12:13], v[20:21] neg_lo:[0,1] neg_hi:[0,1]
    v_pk_add_f32 v[12:13], v[14:15], v[14:15] op_sel:[0,1] op_sel_hi:[1,0] neg_lo:[0,1]
    v_pk_mul_f32 v[12:13], v[12:13], s[56:57]
    v_pk_add_f32 v[14:15], v[18:19], v[18:19] op_sel:[0,1] op_sel_hi:[1,0] neg_lo:[1,1] neg_hi:[1,0]
    v_pk_mul_f32 v[14:15], v[14:15], s[56:57]
    v_pk_add_f32 v[18:19], v[22:23], v[16:17]
    v_pk_add_f32 v[20:21], v[22:23], v[16:17] neg_lo:[0,1] neg_hi:[0,1]
    v_pk_add_f32 v[16:17], v[8:9], v[10:11]
    v_pk_add_f32 v[22:23], v[8:9], v[10:11] neg_lo:[0,1] neg_hi:[0,1]
    v_pk_add_f32 v[8:9], v[18:19], v[16:17]
    v_pk_add_f32 v[10:11], v[18:19], v[16:17] neg_lo:[0,1] neg_hi:[0,1]
    v_pk_add_f32 v[16:17], v[20:21], v[22:23] op_sel:[0,1] op_sel_hi:[1,0] neg_lo:[0,1]
    v_pk_add_f32 v[18:19], v[20:21], v[22:23] op_sel:[0,1] op_sel_hi:[1,0] neg_hi:[0,1]
    v_pk_add_f32 v[20:21], v[26:27], v[24:25] op_sel:[0,1] op_sel_hi:[1,0] neg_lo:[0,1]
    v_pk_add_f32 v[22:23], v[26:27], v[24:25] op_sel:[0,1] op_sel_hi:[1,0] neg_hi:[0,1]
    v_pk_add_f32 v[24:25], v[12:13], v[14:15]
    v_pk_add_f32 v[26:27], v[12:13], v[14:15] neg_lo:[0,1] neg_hi:[0,1]
    v_pk_add_f32 v[12:13], v[20:21], v[24:25]
    v_pk_add_f32 v[14:15], v[20:21], v[24:25] neg_lo:[0,1] neg_hi:[0,1]
    v_pk_add_f32 v[20:21], v[22:23], v[26:27] op_sel:[0,1] op_sel_hi:[1,0] neg_lo:[0,1]
    v_pk_add_f32 v[24:25], v[22:23], v[26:27] op_sel:[0,1] op_sel_hi:[1,0] neg_hi:[0,1]
    buffer_store_dwordx2 v[8:9], v1, s[40:43], s8 offen
    buffer_store_dwordx2 v[12:13], v1, s[40:43], s9 offen
    buffer_store_dwordx2 v[16:17], v1, s[40:43], s10 offen
    buffer_store_dwordx2 v[20:21], v1, s[40:43], s11 offen
    buffer_store_dwordx2 v[10:11], v1, s[40:43], s12 offen
    buffer_store_dwordx2 v[14:15], v1, s[40:43], s13 offen
    buffer_store_dwordx2 v[18:19], v1, s[40:43], s14 offen
    buffer_store_dwordx2 v[24:25], v1, s[40:43], s15 offen
    s_waitcnt vmcnt(0)
    s_endpgm
.Lk2_tr:
    s_sub_u32 s4, s2, 321
    s_cmp_ge_u32 s4, 32
    s_cselect_b32 s36, s20, s16
    s_cselect_b32 s37, s21, s17
    s_cselect_b32 s5, 32, 0
    s_and_b32 s37, s37, 0xffff
    s_mov_b32 s38, 1966080
    s_mov_b32 s39, 0x00020000
    s_sub_u32 s4, s4, s5
    s_mul_i32 s4, s4, 61440
    v_lshlrev_b32 v3, 4, v0
    buffer_load_dwordx4 v[4:7], v3, s[36:39], s4 offen
    s_add_u32 s4, s4, 4096
    buffer_load_dwordx4 v[8:11], v3, s[36:39], s4 offen
    s_add_u32 s4, s4, 4096
    buffer_load_dwordx4 v[12:15], v3, s[36:39], s4 offen
    s_add_u32 s4, s4, 4096
    buffer_load_dwordx4 v[16:19], v3, s[36:39], s4 offen
    s_add_u32 s4, s4, 4096
    buffer_load_dwordx4 v[20:23], v3, s[36:39], s4 offen
    s_add_u32 s4, s4, 4096
    buffer_load_dwordx4 v[24:27], v3, s[36:39], s4 offen
    s_add_u32 s4, s4, 4096
    buffer_load_dwordx4 v[28:31], v3, s[36:39], s4 offen
    s_add_u32 s4, s4, 4096
    buffer_load_dwordx4 v[32:35], v3, s[36:39], s4 offen
    s_add_u32 s4, s4, 4096
    buffer_load_dwordx4 v[36:39], v3, s[36:39], s4 offen
    s_add_u32 s4, s4, 4096
    buffer_load_dwordx4 v[40:43], v3, s[36:39], s4 offen
    s_add_u32 s4, s4, 4096
    buffer_load_dwordx4 v[44:47], v3, s[36:39], s4 offen
    s_add_u32 s4, s4, 4096
    buffer_load_dwordx4 v[48:51], v3, s[36:39], s4 offen
    s_add_u32 s4, s4, 4096
    buffer_load_dwordx4 v[52:55], v3, s[36:39], s4 offen
    s_add_u32 s4, s4, 4096
    buffer_load_dwordx4 v[56:59], v3, s[36:39], s4 offen
    s_add_u32 s4, s4, 4096
    buffer_load_dwordx4 v[60:63], v3, s[36:39], s4 offen
    s_add_u32 s4, s4, 4096
    s_waitcnt vmcnt(0)
.Lk2_end:
    s_endpgm

.globl k3_rowifft_kernel
.p2align 8
.type k3_rowifft_kernel,@function
k3_rowifft_kernel:
    s_cmp_ge_u32 s2, 256
    s_cbranch_scc1 .Lk3_end
    s_and_b32 s4, s2, 7
    s_lshl_b32 s4, s4, 5
    s_lshr_b32 s2, s2, 3
    s_add_u32 s2, s2, s4
    s_load_dwordx2 s[16:17], s[0:1], 0
    s_load_dwordx2 s[24:25], s[0:1], 80
    s_mov_b32 s56, 0x3f3504f3
    s_mov_b32 s57, 0x3f3504f3
    s_mov_b32 s58, 0x3e9e377a
    s_mov_b32 s59, 0x3e9e377a
    s_mov_b32 s60, 0xbf4f1bbd
    s_mov_b32 s61, 0xbf4f1bbd
    s_mov_b32 s62, 0x3f737871
    s_mov_b32 s63, 0x3f737871
    s_mov_b32 s64, 0x3f167918
    s_mov_b32 s65, 0x3f167918
    s_mov_b32 s68, 0x07060302
    s_mov_b32 s66, 0x3acccccd
    s_mov_b32 s67, 0x44200000
    v_lshrrev_b32 v1, 6, v0
    s_waitcnt lgkmcnt(0)
    v_readfirstlane_b32 s3, v1
    s_mov_b32 s40, s24
    s_and_b32 s41, s25, 0xffff
    s_mov_b32 s42, 0x2000000
    s_mov_b32 s43, 0x00020000
    s_mov_b32 s36, s16
    s_and_b32 s37, s17, 0xffff
    s_mov_b32 s38, 0x280000
    s_mov_b32 s39, 0x00020000
    s_mul_i32 s4, s2, 20544
    v_add_u32 v1, 0, v0
    v_lshlrev_b32 v1, 4, v1
    buffer_load_dwordx4 v[4:7], v1, s[40:43], s4 offen
    v_add_u32 v1, 320, v0
    v_lshlrev_b32 v1, 4, v1
    buffer_load_dwordx4 v[8:11], v1, s[40:43], s4 offen
    v_add_u32 v1, 640, v0
    v_lshlrev_b32 v1, 4, v1
    buffer_load_dwordx4 v[12:15], v1, s[40:43], s4 offen
    v_add_u32 v1, 960, v0
    v_lshlrev_b32 v1, 4, v1
    buffer_load_dwordx4 v[16:19], v1, s[40:43], s4 offen
    v_add_u32 v1, 1280, v0
    v_lshlrev_b32 v1, 4, v1
    buffer_load_dwordx4 v[20:23], v1, s[40:43], s4 offen
    v_mul_u32_u24 v2, 205, v0
    v_lshrrev_b32 v2, 14, v2
    v_mul_u32_u24 v3, 80, v2
    v_sub_u32 v3, v0, v3
    v_mul_u32_u24 v24, 205, v3
    v_lshrrev_b32 v24, 11, v24
    v_mul_u32_u24 v25, 10, v24
    v_sub_u32 v25, v3, v25
    v_cvt_f32_u32 v32, v3
    v_mul_f32 v32, 0xbacccccd, v32
    v_mul_f32 v35, 1.0, v32
    v_mul_f32 v37, 2.0, v32
    v_mul_f32 v39, 0x40400000, v32
    v_mul_f32 v41, 4.0, v32
    v_mul_f32 v43, 0x40a00000, v32
    v_mul_f32 v45, 0x40c00000, v32
    v_mul_f32 v47, 0x40e00000, v32
    v_cos_f32 v34, v35
    v_sin_f32 v35, v35
    v_cos_f32 v36, v37
    v_sin_f32 v37, v37
    v_cos_f32 v38, v39
    v_sin_f32 v39, v39
    v_cos_f32 v40, v41
    v_sin_f32 v41, v41
    v_cos_f32 v42, v43
    v_sin_f32 v43, v43
    v_cos_f32 v44, v45
    v_sin_f32 v45, v45
    v_cos_f32 v46, v47
    v_sin_f32 v47, v47
    v_cvt_f32_u32 v48, v25
    v_mul_f32 v48, 0xbc4ccccd, v48
    v_mul_f32 v51, 1.0, v48
    v_mul_f32 v53, 2.0, v48
    v_mul_f32 v55, 0x40400000, v48
    v_mul_f32 v57, 4.0, v48
    v_mul_f32 v59, 0x40a00000, v48
    v_mul_f32 v61, 0x40c00000, v48
    v_mul_f32 v63, 0x40e00000, v48
    v_cos_f32 v50, v51
    v_sin_f32 v51, v51
    v_cos_f32 v52, v53
    v_sin_f32 v53, v53
    v_cos_f32 v54, v55
    v_sin_f32 v55, v55
    v_cos_f32 v56, v57
    v_sin_f32 v57, v57
    v_cos_f32 v58, v59
    v_sin_f32 v59, v59
    v_cos_f32 v60, v61
    v_sin_f32 v61, v61
    v_cos_f32 v62, v63
    v_sin_f32 v63, v63
    v_and_b32 v30, 63, v0
    s_lshl_b32 s5, s2, 3
    s_and_b32 s6, s3, 3
    s_lshl_b32 s6, s6, 1
    s_add_u32 s5, s5, s6
    s_mul_i32 s5, s5, 1280
    v_mul_u32_u24 v31, 20, v30
    buffer_load_dwordx4 v[64:67], v31, s[36:39], s5 offen
    buffer_load_dword v68, v31, s[36:39], s5 offen offset:16
    buffer_load_dwordx4 v[72:75], v31, s[36:39], s5 offen offset:1280
    buffer_load_dword v69, v31, s[36:39], s5 offen offset:1296
    s_waitcnt vmcnt(4)
    v_add_u32 v1, 0, v0
    v_lshrrev_b32 v29, 2, v1
    v_and_b32 v26, 3, v1
    v_mul_u32_u24 v26, 648, v26
    v_add_u32 v27, v26, v29
    v_sub_u32 v28, 640, v29
    v_add_u32 v28, v28, v26
    v_lshlrev_b32 v27, 3, v27
    v_lshlrev_b32 v28, 3, v28
    v_cmp_eq_u32 vcc, 0, v29
    s_nop 1
    v_cndmask_b32 v5, v5, 0, vcc
    v_cndmask_b32 v7, v7, 0, vcc
    v_sub_f32 v76, v4, v7
    v_add_f32 v77, v5, v6
    v_add_f32 v78, v4, v7
    v_sub_f32 v79, v6, v5
    ds_write_b64 v27, v[76:77] offset:22528
    ds_write_b64 v28, v[78:79] offset:22528
    v_add_u32 v1, 320, v0
    v_lshrrev_b32 v29, 2, v1
    v_and_b32 v26, 3, v1
    v_mul_u32_u24 v26, 648, v26
    v_add_u32 v27, v26, v29
    v_sub_u32 v28, 640, v29
    v_add_u32 v28, v28, v26
    v_lshlrev_b32 v27, 3, v27
    v_lshlrev_b32 v28, 3, v28
    v_sub_f32 v76, v8, v11
    v_add_f32 v77, v9, v10
    v_add_f32 v78, v8, v11
    v_sub_f32 v79, v10, v9
    ds_write_b64 v27, v[76:77] offset:22528
    ds_write_b64 v28, v[78:79] offset:22528
    v_add_u32 v1, 640, v0
    v_lshrrev_b32 v29, 2, v1
    v_and_b32 v26, 3, v1
    v_mul_u32_u24 v26, 648, v26
    v_add_u32 v27, v26, v29
    v_sub_u32 v28, 640, v29
    v_add_u32 v28, v28, v26
    v_lshlrev_b32 v27, 3, v27
    v_lshlrev_b32 v28, 3, v28
    v_sub_f32 v76, v12, v15
    v_add_f32 v77, v13, v14
    v_add_f32 v78, v12, v15
    v_sub_f32 v79, v14, v13
    ds_write_b64 v27, v[76:77] offset:22528
    ds_write_b64 v28, v[78:79] offset:22528
    v_add_u32 v1, 960, v0
    v_lshrrev_b32 v29, 2, v1
    v_and_b32 v26, 3, v1
    v_mul_u32_u24 v26, 648, v26
    v_add_u32 v27, v26, v29
    v_sub_u32 v28, 640, v29
    v_add_u32 v28, v28, v26
    v_lshlrev_b32 v27, 3, v27
    v_lshlrev_b32 v28, 3, v28
    v_sub_f32 v76, v16, v19
    v_add_f32 v77, v17, v18
    v_add_f32 v78, v16, v19
    v_sub_f32 v79, v18, v17
    ds_write_b64 v27, v[76:77] offset:22528
    ds_write_b64 v28, v[78:79] offset:22528
    v_add_u32 v1, 1280, v0
    v_lshrrev_b32 v29, 2, v1
    v_and_b32 v26, 3, v1
    v_mul_u32_u24 v26, 648, v26
    v_add_u32 v27, v26, v29
    v_sub_u32 v28, 640, v29
    v_add_u32 v28, v28, v26
    v_lshlrev_b32 v27, 3, v27
    v_lshlrev_b32 v28, 3, v28
    v_cmp_eq_u32 vcc, 320, v29
    s_nop 1
    v_cndmask_b32 v21, v21, 0, vcc
    v_cndmask_b32 v23, v23, 0, vcc
    v_sub_f32 v76, v20, v23
    v_add_f32 v77, v21, v22
    v_add_f32 v78, v20, v23
    v_sub_f32 v79, v22, v21
    v_cmp_gt_u32 vcc, 1284, v1
    s_and_saveexec_b64 s[6:7], vcc
    ds_write_b64 v27, v[76:77] offset:22528
    ds_write_b64 v28, v[78:79] offset:22528
    s_mov_b64 exec, s[6:7]
    s_waitcnt lgkmcnt(0)
    s_barrier
    s_cmp_ge_u32 s3, 4
    s_cbranch_scc1 .Lk3_b1
    s_mul_i32 s6, s3, 648*8
    v_lshlrev_b32 v27, 3, v30
    v_add_u32 v27, s6, v27
    ds_read_b64 v[4:5], v27 offset:22528
    ds_read_b64 v[6:7], v27 offset:23040
    ds_read_b64 v[8:9], v27 offset:23552
    ds_read_b64 v[10:11], v27 offset:24064
    ds_read_b64 v[12:13], v27 offset:24576
    ds_read_b64 v[14:15], v27 offset:25088
    ds_read_b64 v[16:17], v27 offset:25600
    ds_read_b64 v[18:19], v27 offset:26112
    ds_read_b64 v[20:21], v27 offset:26624
    ds_read_b64 v[22:23], v27 offset:27136
    s_mul_i32 s6, s3, 704*8
    v_mul_u32_u24 v27, 88, v30
    v_add_u32 v27, s6, v27
    s_waitcnt lgkmcnt(0)
    v_pk_add_f32 v[28:29], v[8:9], v[20:21]
    v_pk_add_f32 v[76:77], v[8:9], v[20:21] neg_lo:[0,1] neg_hi:[0,1]
    v_pk_add_f32 v[78:79], v[12:13], v[16:17]
    v_pk_add_f32 v[80:81], v[12:13], v[16:17] neg_lo:[0,1] neg_hi:[0,1]
    v_pk_add_f32 v[8:9], v[28:29], v[78:79]
    v_pk_add_f32 v[12:13], v[4:5], v[8:9]
    v_pk_fma_f32 v[8:9], v[28:29], s[58:59], v[4:5]
    v_pk_fma_f32 v[8:9], v[78:79], s[60:61], v[8:9]
    v_pk_fma_f32 v[16:17], v[28:29], s[60:61], v[4:5]
    v_pk_fma_f32 v[16:17], v[78:79], s[58:59], v[16:17]
    v_pk_mul_f32 v[4:5], v[76:77], s[62:63]
    v_pk_fma_f32 v[4:5], v[80:81], s[64:65], v[4:5]
    v_pk_mul_f32 v[20:21], v[76:77], s[64:65]
    v_pk_fma_f32 v[20:21], v[80:81], s[62:63], v[20:21] neg_lo:[1,0,0] neg_hi:[1,0,0]
    v_pk_add_f32 v[28:29], v[8:9], v[4:5] op_sel:[0,1] op_sel_hi:[1,0] neg_lo:[0,1]
    v_pk_add_f32 v[76:77], v[8:9], v[4:5] op_sel:[0,1] op_sel_hi:[1,0] neg_hi:[0,1]
    v_pk_add_f32 v[78:79], v[16:17], v[20:21] op_sel:[0,1] op_sel_hi:[1,0] neg_lo:[0,1]
    v_pk_add_f32 v[80:81], v[16:17], v[20:21] op_sel:[0,1] op_sel_hi:[1,0] neg_hi:[0,1]
    v_pk_add_f32 v[4:5], v[18:19], v[10:11]
    v_pk_add_f32 v[8:9], v[18:19], v[10:11] neg_lo:[0,1] neg_hi:[0,1]
    v_pk_add_f32 v[16:17], v[22:23], v[6:7]
    v_pk_add_f32 v[20:21], v[22:23], v[6:7] neg_lo:[0,1] neg_hi:[0,1]
    v_pk_add_f32 v[6:7], v[4:5], v[16:17]
    v_pk_add_f32 v[10:11], v[14:15], v[6:7]
    v_pk_fma_f32 v[6:7], v[4:5], s[58:59], v[14:15]
    v_pk_fma_f32 v[6:7], v[16:17], s[60:61], v[6:7]
    v_pk_fma_f32 v[18:19], v[4:5], s[60:61], v[14:15]
    v_pk_fma_f32 v[18:19], v[16:17], s[58:59], v[18:19]
    v_pk_mul_f32 v[4:5], v[8:9], s[62:63]
    v_pk_fma_f32 v[4:5], v[20:21], s[64:65], v[4:5]
    v_pk_mul_f32 v[14:15], v[8:9], s[64:65]
    v_pk_fma_f32 v[14:15], v[20:21], s[62:63], v[14:15] neg_lo:[1,0,0] neg_hi:[1,0,0]
    v_pk_add_f32 v[8:9], v[6:7], v[4:5] op_sel:[0,1] op_sel_hi:[1,0] neg_lo:[0,1]
    v_pk_add_f32 v[16:17], v[6:7], v[4:5] op_sel:[0,1] op_sel_hi:[1,0] neg_hi:[0,1]
    v_pk_add_f32 v[20:21], v[18:19], v[14:15] op_sel:[0,1] op_sel_hi:[1,0] neg_lo:[0,1]
    v_pk_add_f32 v[22:23], v[18:19], v[14:15] op_sel:[0,1] op_sel_hi:[1,0] neg_hi:[0,1]
    v_pk_add_f32 v[4:5], v[12:13], v[10:11]
    v_pk_add_f32 v[6:7], v[12:13], v[10:11] neg_lo:[0,1] neg_hi:[0,1]
    v_pk_add_f32 v[10:11], v[28:29], v[8:9]
    v_pk_add_f32 v[12:13], v[28:29], v[8:9] neg_lo:[0,1] neg_hi:[0,1]
    v_pk_add_f32 v[8:9], v[78:79], v[20:21]
    v_pk_add_f32 v[14:15], v[78:79], v[20:21] neg_lo:[0,1] neg_hi:[0,1]
    v_pk_add_f32 v[18:19], v[80:81], v[22:23]
    v_pk_add_f32 v[20:21], v[80:81], v[22:23] neg_lo:[0,1] neg_hi:[0,1]
    v_pk_add_f32 v[22:23], v[76:77], v[16:17]
    v_pk_add_f32 v[28:29], v[76:77], v[16:17] neg_lo:[0,1] neg_hi:[0,1]
    ds_write_b64 v27, v[4:5] offset:0
    ds_write_b64 v27, v[12:13] offset:8
    ds_write_b64 v27, v[8:9] offset:16
    ds_write_b64 v27, v[20:21] offset:24
    ds_write_b64 v27, v[22:23] offset:32
    ds_write_b64 v27, v[6:7] offset:40
    ds_write_b64 v27, v[10:11] offset:48
    ds_write_b64 v27, v[14:15] offset:56
    ds_write_b64 v27, v[18:19] offset:64
    ds_write_b64 v27, v[28:29] offset:72
.Lk3_b1:
    s_waitcnt lgkmcnt(0)
    s_barrier
    v_mul_u32_u24 v27, 704, v2
    v_mul_u32_u24 v26, 11, v24
    v_add3_u32 v27, v27, v26, v25
    v_lshlrev_b32 v27, 3, v27
    ds_read_b64 v[4:5], v27 offset:0
    ds_read_b64 v[6:7], v27 offset:704
    ds_read_b64 v[8:9], v27 offset:1408
    ds_read_b64 v[10:11], v27 offset:2112
    ds_read_b64 v[12:13], v27 offset:2816
    ds_read_b64 v[14:15], v27 offset:3520
    ds_read_b64 v[16:17], v27 offset:4224
    ds_read_b64 v[18:19], v27 offset:4928
    v_mul_u32_u24 v27, 848, v2
    v_mul_u32_u24 v26, 106, v24
    v_add3_u32 v27, v27, v26, v25
    v_lshlrev_b32 v27, 3, v27
    s_waitcnt lgkmcnt(0)
    v_pk_mul_f32 v[20:21], v[6:7], v[50:51] op_sel_hi:[0,1] neg_hi:[0,1]
    v_pk_fma_f32 v[20:21], v[6:7], v[50:51], v[20:21] op_sel:[1,1,0] op_sel_hi:[1,0,1]
    v_pk_mul_f32 v[6:7], v[8:9], v[52:53] op_sel_hi:[0,1] neg_hi:[0,1]
    v_pk_fma_f32 v[6:7], v[8:9], v[52:53], v[6:7] op_sel:[1,1,0] op_sel_hi:[1,0,1]
    v_pk_mul_f32 v[8:9], v[10:11], v[54:55] op_sel_hi:[0,1] neg_hi:[0,1]
    v_pk_fma_f32 v[8:9], v[10:11], v[54:55], v[8:9] op_sel:[1,1,0] op_sel_hi:[1,0,1]
    v_pk_mul_f32 v[10:11], v[12:13], v[56:57] op_sel_hi:[0,1] neg_hi:[0,1]
    v_pk_fma_f32 v[10:11], v[12:13], v[56:57], v[10:11] op_sel:[1,1,0] op_sel_hi:[1,0,1]
    v_pk_mul_f32 v[12:13], v[14:15], v[58:59] op_sel_hi:[0,1] neg_hi:[0,1]
    v_pk_fma_f32 v[12:13], v[14:15], v[58:59], v[12:13] op_sel:[1,1,0] op_sel_hi:[1,0,1]
    v_pk_mul_f32 v[14:15], v[16:17], v[60:61] op_sel_hi:[0,1] neg_hi:[0,1]
    v_pk_fma_f32 v[14:15], v[16:17], v[60:61], v[14:15] op_sel:[1,1,0] op_sel_hi:[1,0,1]
    v_pk_mul_f32 v[16:17], v[18:19], v[62:63] op_sel_hi:[0,1] neg_hi:[0,1]
    v_pk_fma_f32 v[16:17], v[18:19], v[62:63], v[16:17] op_sel:[1,1,0] op_sel_hi:[1,0,1]
    v_pk_add_f32 v[18:19], v[4:5], v[10:11]
    v_pk_add_f32 v[22:23], v[4:5], v[10:11] neg_lo:[0,1] neg_hi:[0,1]
    v_pk_add_f32 v[4:5], v[20:21], v[12:13]
    v_pk_add_f32 v[10:11], v[20:21], v[12:13] neg_lo:[0,1] neg_hi:[0,1]
    v_pk_add_f32 v[12:13], v[6:7], v[14:15]
    v_pk_add_f32 v[20:21], v[6:7], v[14:15] neg_lo:[0,1] neg_hi:[0,1]
    v_pk_add_f32 v[6:7], v[8:9], v[16:17]
    v_pk_add_f32 v[14:15], v[8:9], v[16:17] neg_lo:[0,1] neg_hi:[0,1]
    v_pk_add_f32 v[8:9], v[10:11], v[10:11] op_sel:[0,1] op_sel_hi:[1,0] neg_lo:[0,1]
    v_pk_mul_f32 v[8:9], v[8:9], s[56:57]
    v_pk_add_f32 v[10:11], v[14:15], v[14:15] op_sel:[0,1] op_sel_hi:[1,0] neg_lo:[1,1] neg_hi:[1,0]
    v_pk_mul_f32 v[10:11], v[10:11], s[56:57]
    v_pk_add_f32 v[14:15], v[18:19], v[12:13]
    v_pk_add_f32 v[16:17], v[18:19], v[12:13] neg_lo:[0,1] neg_hi:[0,1]
    v_pk_add_f32 v[12:13], v[4:5], v[6:7]
    v_pk_add_f32 v[18:19], v[4:5], v[6:7] neg_lo:[0,1] neg_hi:[0,1]
    v_pk_add_f32 v[4:5], v[14:15], v[12:13]
    v_pk_add_f32 v[6:7], v[14:15], v[12:13] neg_lo:[0,1] neg_hi:[0,1]
    v_pk_add_f32 v[12:13], v[16:17], v[18:19] op_sel:[0,1] op_sel_hi:[1,0] neg_lo:[0,1]
    v_pk_add_f32 v[14:15], v[16:17], v[18:19] op_sel:[0,1] op_sel_hi:[1,0] neg_hi:[0,1]
    v_pk_add_f32 v[16:17], v[22:23], v[20:21] op_sel:[0,1] op_sel_hi:[1,0] neg_lo:[0,1]
    v_pk_add_f32 v[18:19], v[22:23], v[20:21] op_sel:[0,1] op_sel_hi:[1,0] neg_hi:[0,1]
    v_pk_add_f32 v[20:21], v[8:9], v[10:11]
    v_pk_add_f32 v[22:23], v[8:9], v[10:11] neg_lo:[0,1] neg_hi:[0,1]
    v_pk_add_f32 v[8:9], v[16:17], v[20:21]
    v_pk_add_f32 v[10:11], v[16:17], v[20:21] neg_lo:[0,1] neg_hi:[0,1]
    v_pk_add_f32 v[16:17], v[18:19], v[22:23] op_sel:[0,1] op_sel_hi:[1,0] neg_lo:[0,1]
    v_pk_add_f32 v[20:21], v[18:19], v[22:23] op_sel:[0,1] op_sel_hi:[1,0] neg_hi:[0,1]
    ds_write_b64 v27, v[4:5] offset:22528
    ds_write_b64 v27, v[8:9] offset:22608
    ds_write_b64 v27, v[12:13] offset:22688
    ds_write_b64 v27, v[16:17] offset:22768
    ds_write_b64 v27, v[6:7] offset:22848
    ds_write_b64 v27, v[10:11] offset:22928
    ds_write_b64 v27, v[14:15] offset:23008
    ds_write_b64 v27, v[20:21] offset:23088
    s_waitcnt lgkmcnt(0)
    s_barrier
    v_mul_u32_u24 v27, 848, v2
    v_add_u32 v27, v27, v3
    v_lshlrev_b32 v27, 3, v27
    ds_read_b64 v[4:5], v27 offset:22528
    ds_read_b64 v[6:7], v27 offset:23376
    ds_read_b64 v[8:9], v27 offset:24224
    ds_read_b64 v[10:11], v27 offset:25072
    ds_read_b64 v[12:13], v27 offset:25920
    ds_read_b64 v[14:15], v27 offset:26768
    ds_read_b64 v[16:17], v27 offset:27616
    ds_read_b64 v[18:19], v27 offset:28464
    v_mul_u32_u24 v27, 640, v2
    v_add_u32 v27, v27, v3
    v_lshlrev_b32 v27, 3, v27
    s_waitcnt lgkmcnt(0)
    v_pk_mul_f32 v[20:21], v[6:7], v[34:35] op_sel_hi:[0,1] neg_hi:[0,1]
    v_pk_fma_f32 v[20:21], v[6:7], v[34:35], v[20:21] op_sel:[1,1,0] op_sel_hi:[1,0,1]
    v_pk_mul_f32 v[6:7], v[8:9], v[36:37] op_sel_hi:[0,1] neg_hi:[0,1]
    v_pk_fma_f32 v[6:7], v[8:9], v[36:37], v[6:7] op_sel:[1,1,0] op_sel_hi:[1,0,1]
    v_pk_mul_f32 v[8:9], v[10:11], v[38:39] op_sel_hi:[0,1] neg_hi:[0,1]
    v_pk_fma_f32 v[8:9], v[10:11], v[38:39], v[8:9] op_sel:[1,1,0] op_sel_hi:[1,0,1]
    v_pk_mul_f32 v[10:11], v[12:13], v[40:41] op_sel_hi:[0,1] neg_hi:[0,1]
    v_pk_fma_f32 v[10:11], v[12:13], v[40:41], v[10:11] op_sel:[1,1,0] op_sel_hi:[1,0,1]
    v_pk_mul_f32 v[12:13], v[14:15], v[42:43] op_sel_hi:[0,1] neg_hi:[0,1]
    v_pk_fma_f32 v[12:13], v[14:15], v[42:43], v[12:13] op_sel:[1,1,0] op_sel_hi:[1,0,1]
    v_pk_mul_f32 v[14:15], v[16:17], v[44:45] op_sel_hi:[0,1] neg_hi:[0,1]
    v_pk_fma_f32 v[14:15], v[16:17], v[44:45], v[14:15] op_sel:[1,1,0] op_sel_hi:[1,0,1]
    v_pk_mul_f32 v[16:17], v[18:19], v[46:47] op_sel_hi:[0,1] neg_hi:[0,1]
    v_pk_fma_f32 v[16:17], v[18:19], v[46:47], v[16:17] op_sel:[1,1,0] op_sel_hi:[1,0,1]
    v_pk_add_f32 v[18:19], v[4:5], v[10:11]
    v_pk_add_f32 v[22:23], v[4:5], v[10:11] neg_lo:[0,1] neg_hi:[0,1]
    v_pk_add_f32 v[4:5], v[20:21], v[12:13]
    v_pk_add_f32 v[10:11], v[20:21], v[12:13] neg_lo:[0,1] neg_hi:[0,1]
    v_pk_add_f32 v[12:13], v[6:7], v[14:15]
    v_pk_add_f32 v[20:21], v[6:7], v[14:15] neg_lo:[0,1] neg_hi:[0,1]
    v_pk_add_f32 v[6:7], v[8:9], v[16:17]
    v_pk_add_f32 v[14:15], v[8:9], v[16:17] neg_lo:[0,1] neg_hi:[0,1]
    v_pk_add_f32 v[8:9], v[10:11], v[10:11] op_sel:[0,1] op_sel_hi:[1,0] neg_lo:[0,1]
    v_pk_mul_f32 v[8:9], v[8:9], s[56:57]
    v_pk_add_f32 v[10:11], v[14:15], v[14:15] op_sel:[0,1] op_sel_hi:[1,0] neg_lo:[1,1] neg_hi:[1,0]
    v_pk_mul_f32 v[10:11], v[10:11], s[56:57]
    v_pk_add_f32 v[14:15], v[18:19], v[12:13]
    v_pk_add_f32 v[16:17], v[18:19], v[12:13] neg_lo:[0,1] neg_hi:[0,1]
    v_pk_add_f32 v[12:13], v[4:5], v[6:7]
    v_pk_add_f32 v[18:19], v[4:5], v[6:7] neg_lo:[0,1] neg_hi:[0,1]
    v_pk_add_f32 v[4:5], v[14:15], v[12:13]
    v_pk_add_f32 v[6:7], v[14:15], v[12:13] neg_lo:[0,1] neg_hi:[0,1]
    v_pk_add_f32 v[12:13], v[16:17], v[18:19] op_sel:[0,1] op_sel_hi:[1,0] neg_lo:[0,1]
    v_pk_add_f32 v[14:15], v[16:17], v[18:19] op_sel:[0,1] op_sel_hi:[1,0] neg_hi:[0,1]
    v_pk_add_f32 v[16:17], v[22:23], v[20:21] op_sel:[0,1] op_sel_hi:[1,0] neg_lo:[0,1]
    v_pk_add_f32 v[18:19], v[22:23], v[20:21] op_sel:[0,1] op_sel_hi:[1,0] neg_hi:[0,1]
    v_pk_add_f32 v[20:21], v[8:9], v[10:11]
    v_pk_add_f32 v[22:23], v[8:9], v[10:11] neg_lo:[0,1] neg_hi:[0,1]
    v_pk_add_f32 v[8:9], v[16:17], v[20:21]
    v_pk_add_f32 v[10:11], v[16:17], v[20:21] neg_lo:[0,1] neg_hi:[0,1]
    v_pk_add_f32 v[16:17], v[18:19], v[22:23] op_sel:[0,1] op_sel_hi:[1,0] neg_lo:[0,1]
    v_pk_add_f32 v[20:21], v[18:19], v[22:23] op_sel:[0,1] op_sel_hi:[1,0] neg_hi:[0,1]
    ds_write_b64 v27, v[4:5] offset:0
    ds_write_b64 v27, v[8:9] offset:640
    ds_write_b64 v27, v[12:13] offset:1280
    ds_write_b64 v27, v[16:17] offset:1920
    ds_write_b64 v27, v[6:7] offset:2560
    ds_write_b64 v27, v[10:11] offset:3200
    ds_write_b64 v27, v[14:15] offset:3840
    ds_write_b64 v27, v[20:21] offset:4480
    s_waitcnt lgkmcnt(0)
    s_barrier
    s_cmp_ge_u32 s3, 4
    s_cbranch_scc1 .Lk3_end
    s_mul_i32 s6, s3, 5120
    v_mul_u32_u24 v27, 80, v30
    v_add_u32 v27, s6, v27
    ds_read_b128 v[4:7], v27 offset:0
    ds_read_b128 v[8:11], v27 offset:16
    ds_read_b128 v[12:15], v27 offset:32
    ds_read_b128 v[16:19], v27 offset:48
    ds_read_b128 v[20:23], v27 offset:64
    s_waitcnt vmcnt(0) lgkmcnt(0)
    v_cvt_pk_bf16_f32 v26, v4, v6
    v_lshlrev_b32 v4, 16, v26
    v_and_b32 v6, 0xffff0000, v26
    v_lshlrev_b32 v26, 16, v64
    v_and_b32 v1, 0xffff0000, v64
    v_add_f32 v4, v4, v26
    v_add_f32 v6, v6, v1
    v_cvt_pk_bf16_f32 v32, v4, v6
    v_lshlrev_b32 v4, 16, v32
    v_and_b32 v6, 0xffff0000, v32
    v_cvt_pk_bf16_f32 v26, v5, v7
    v_lshlrev_b32 v5, 16, v26
    v_and_b32 v7, 0xffff0000, v26
    v_lshlrev_b32 v26, 16, v72
    v_and_b32 v1, 0xffff0000, v72
    v_add_f32 v5, v5, v26
    v_add_f32 v7, v7, v1
    v_cvt_pk_bf16_f32 v40, v5, v7
    v_lshlrev_b32 v5, 16, v40
    v_and_b32 v7, 0xffff0000, v40
    v_cvt_pk_bf16_f32 v26, v8, v10
    v_lshlrev_b32 v8, 16, v26
    v_and_b32 v10, 0xffff0000, v26
    v_lshlrev_b32 v26, 16, v65
    v_and_b32 v1, 0xffff0000, v65
    v_add_f32 v8, v8, v26
    v_add_f32 v10, v10, v1
    v_cvt_pk_bf16_f32 v33, v8, v10
    v_lshlrev_b32 v8, 16, v33
    v_and_b32 v10, 0xffff0000, v33
    v_cvt_pk_bf16_f32 v26, v9, v11
    v_lshlrev_b32 v9, 16, v26
    v_and_b32 v11, 0xffff0000, v26
    v_lshlrev_b32 v26, 16, v73
    v_and_b32 v1, 0xffff0000, v73
    v_add_f32 v9, v9, v26
    v_add_f32 v11, v11, v1
    v_cvt_pk_bf16_f32 v41, v9, v11
    v_lshlrev_b32 v9, 16, v41
    v_and_b32 v11, 0xffff0000, v41
    v_cvt_pk_bf16_f32 v26, v12, v14
    v_lshlrev_b32 v12, 16, v26
    v_and_b32 v14, 0xffff0000, v26
    v_lshlrev_b32 v26, 16, v66
    v_and_b32 v1, 0xffff0000, v66
    v_add_f32 v12, v12, v26
    v_add_f32 v14, v14, v1
    v_cvt_pk_bf16_f32 v34, v12, v14
    v_lshlrev_b32 v12, 16, v34
    v_and_b32 v14, 0xffff0000, v34
    v_cvt_pk_bf16_f32 v26, v13, v15
    v_lshlrev_b32 v13, 16, v26
    v_and_b32 v15, 0xffff0000, v26
    v_lshlrev_b32 v26, 16, v74
    v_and_b32 v1, 0xffff0000, v74
    v_add_f32 v13, v13, v26
    v_add_f32 v15, v15, v1
    v_cvt_pk_bf16_f32 v42, v13, v15
    v_lshlrev_b32 v13, 16, v42
    v_and_b32 v15, 0xffff0000, v42
    v_cvt_pk_bf16_f32 v26, v16, v18
    v_lshlrev_b32 v16, 16, v26
    v_and_b32 v18, 0xffff0000, v26
    v_lshlrev_b32 v26, 16, v67
    v_and_b32 v1, 0xffff0000, v67
    v_add_f32 v16, v16, v26
    v_add_f32 v18, v18, v1
    v_cvt_pk_bf16_f32 v35, v16, v18
    v_lshlrev_b32 v16, 16, v35
    v_and_b32 v18, 0xffff0000, v35
    v_cvt_pk_bf16_f32 v26, v17, v19
    v_lshlrev_b32 v17, 16, v26
    v_and_b32 v19, 0xffff0000, v26
    v_lshlrev_b32 v26, 16, v75
    v_and_b32 v1, 0xffff0000, v75
    v_add_f32 v17, v17, v26
    v_add_f32 v19, v19, v1
    v_cvt_pk_bf16_f32 v43, v17, v19
    v_lshlrev_b32 v17, 16, v43
    v_and_b32 v19, 0xffff0000, v43
    v_cvt_pk_bf16_f32 v26, v20, v22
    v_lshlrev_b32 v20, 16, v26
    v_and_b32 v22, 0xffff0000, v26
    v_lshlrev_b32 v26, 16, v68
    v_and_b32 v1, 0xffff0000, v68
    v_add_f32 v20, v20, v26
    v_add_f32 v22, v22, v1
    v_cvt_pk_bf16_f32 v36, v20, v22
    v_lshlrev_b32 v20, 16, v36
    v_and_b32 v22, 0xffff0000, v36
    v_cvt_pk_bf16_f32 v26, v21, v23
    v_lshlrev_b32 v21, 16, v26
    v_and_b32 v23, 0xffff0000, v26
    v_lshlrev_b32 v26, 16, v69
    v_and_b32 v1, 0xffff0000, v69
    v_add_f32 v21, v21, v26
    v_add_f32 v23, v23, v1
    v_cvt_pk_bf16_f32 v37, v21, v23
    v_lshlrev_b32 v21, 16, v37
    v_and_b32 v23, 0xffff0000, v37
    s_add_u32 s6, s5, 8388608
    buffer_store_dwordx4 v[32:35], v31, s[40:43], s6 offen
    buffer_store_dword v36, v31, s[40:43], s6 offen offset:16
    buffer_store_dwordx4 v[40:43], v31, s[40:43], s6 offen offset:1280
    buffer_store_dword v37, v31, s[40:43], s6 offen offset:1296
    v_add_f32 v28, v4, v6
    v_add_f32 v28, v28, v8
    v_add_f32 v28, v28, v10
    v_add_f32 v28, v28, v12
    v_add_f32 v28, v28, v14
    v_add_f32 v28, v28, v16
    v_add_f32 v28, v28, v18
    v_add_f32 v28, v28, v20
    v_add_f32 v28, v28, v22
    v_add_f32 v29, v5, v7
    v_add_f32 v29, v29, v9
    v_add_f32 v29, v29, v11
    v_add_f32 v29, v29, v13
    v_add_f32 v29, v29, v15
    v_add_f32 v29, v29, v17
    v_add_f32 v29, v29, v19
    v_add_f32 v29, v29, v21
    v_add_f32 v29, v29, v23
    v_add_f32_dpp v28, v28, v28 quad_perm:[1,0,3,2] row_mask:0xf bank_mask:0xf
    s_nop 0
    v_add_f32_dpp v29, v29, v29 quad_perm:[1,0,3,2] row_mask:0xf bank_mask:0xf
    v_add_f32_dpp v28, v28, v28 quad_perm:[2,3,0,1] row_mask:0xf bank_mask:0xf
    s_nop 0
    v_add_f32_dpp v29, v29, v29 quad_perm:[2,3,0,1] row_mask:0xf bank_mask:0xf
    v_add_f32_dpp v28, v28, v28 row_half_mirror row_mask:0xf bank_mask:0xf
    s_nop 0
    v_add_f32_dpp v29, v29, v29 row_half_mirror row_mask:0xf bank_mask:0xf
    v_add_f32_dpp v28, v28, v28 row_mirror row_mask:0xf bank_mask:0xf
    s_nop 0
    v_add_f32_dpp v29, v29, v29 row_mirror row_mask:0xf bank_mask:0xf
    v_readlane_b32 s70, v28, 0
    v_readlane_b32 s71, v28, 16
    v_readlane_b32 s72, v28, 32
    v_readlane_b32 s73, v28, 48
    v_readlane_b32 s74, v29, 0
    v_readlane_b32 s75, v29, 16
    v_readlane_b32 s76, v29, 32
    v_readlane_b32 s77, v29, 48
    v_mov_b32 v28, s70
    v_add_f32 v28, s71, v28
    v_mov_b32 v44, s72
    v_add_f32 v44, s73, v44
    v_add_f32 v28, v28, v44
    v_mov_b32 v29, s74
    v_add_f32 v29, s75, v29
    v_mov_b32 v44, s76
    v_add_f32 v44, s77, v44
    v_add_f32 v29, v29, v44
    v_mul_f32 v44, s66, v28
    v_fma_f32 v45, -v44, s67, v28
    v_fma_f32 v44, v45, s66, v44
    v_mul_f32 v28, s66, v29
    v_fma_f32 v45, -v28, s67, v29
    v_fma_f32 v28, v45, s66, v28
    v_sub_f32 v45, v4, v44
    v_mul_f32 v29, v45, v45
    v_sub_f32 v45, v6, v44
    v_fmac_f32 v29, v45, v45
    v_sub_f32 v45, v8, v44
    v_fmac_f32 v29, v45, v45
    v_sub_f32 v45, v10, v44
    v_fmac_f32 v29, v45, v45
    v_sub_f32 v45, v12, v44
    v_fmac_f32 v29, v45, v45
    v_sub_f32 v45, v14, v44
    v_fmac_f32 v29, v45, v45
    v_sub_f32 v45, v16, v44
    v_fmac_f32 v29, v45, v45
    v_sub_f32 v45, v18, v44
    v_fmac_f32 v29, v45, v45
    v_sub_f32 v45, v20, v44
    v_fmac_f32 v29, v45, v45
    v_sub_f32 v45, v22, v44
    v_fmac_f32 v29, v45, v45
    v_sub_f32 v46, v5, v28
    v_mul_f32 v45, v46, v46
    v_sub_f32 v46, v7, v28
    v_fmac_f32 v45, v46, v46
    v_sub_f32 v46, v9, v28
    v_fmac_f32 v45, v46, v46
    v_sub_f32 v46, v11, v28
    v_fmac_f32 v45, v46, v46
    v_sub_f32 v46, v13, v28
    v_fmac_f32 v45, v46, v46
    v_sub_f32 v46, v15, v28
    v_fmac_f32 v45, v46, v46
    v_sub_f32 v46, v17, v28
    v_fmac_f32 v45, v46, v46
    v_sub_f32 v46, v19, v28
    v_fmac_f32 v45, v46, v46
    v_sub_f32 v46, v21, v28
    v_fmac_f32 v45, v46, v46
    v_sub_f32 v46, v23, v28
    v_fmac_f32 v45, v46, v46
    v_add_f32_dpp v29, v29, v29 quad_perm:[1,0,3,2] row_mask:0xf bank_mask:0xf
    s_nop 0
    v_add_f32_dpp v45, v45, v45 quad_perm:[1,0,3,2] row_mask:0xf bank_mask:0xf
    v_add_f32_dpp v29, v29, v29 quad_perm:[2,3,0,1] row_mask:0xf bank_mask:0xf
    s_nop 0
    v_add_f32_dpp v45, v45, v45 quad_perm:[2,3,0,1] row_mask:0xf bank_mask:0xf
    v_add_f32_dpp v29, v29, v29 row_half_mirror row_mask:0xf bank_mask:0xf
    s_nop 0
    v_add_f32_dpp v45, v45, v45 row_half_mirror row_mask:0xf bank_mask:0xf
    v_add_f32_dpp v29, v29, v29 row_mirror row_mask:0xf bank_mask:0xf
    s_nop 0
    v_add_f32_dpp v45, v45, v45 row_mirror row_mask:0xf bank_mask:0xf
    v_readlane_b32 s70, v29, 0
    v_readlane_b32 s71, v29, 16
    v_readlane_b32 s72, v29, 32
    v_readlane_b32 s73, v29, 48
    v_readlane_b32 s74, v45, 0
    v_readlane_b32 s75, v45, 16
    v_readlane_b32 s76, v45, 32
    v_readlane_b32 s77, v45, 48
    v_mov_b32 v29, s70
    v_add_f32 v29, s71, v29
    v_mov_b32 v46, s72
    v_add_f32 v46, s73, v46
    v_add_f32 v29, v29, v46
    v_mov_b32 v45, s74
    v_add_f32 v45, s75, v45
    v_mov_b32 v46, s76
    v_add_f32 v46, s77, v46
    v_add_f32 v45, v45, v46
    v_mul_f32 v46, s66, v29
    v_fma_f32 v47, -v46, s67, v29
    v_fma_f32 v46, v47, s66, v46
    v_cvt_pk_bf16_f32 v46, v46, v46
    v_lshlrev_b32 v46, 16, v46
    v_add_f32 v46, 0x3727c5ac, v46
    v_cvt_pk_bf16_f32 v46, v46, v46
    v_lshlrev_b32 v46, 16, v46
    v_sqrt_f32 v46, v46
    s_nop 0
    v_cvt_pk_bf16_f32 v46, v46, v46
    v_lshlrev_b32 v46, 16, v46
    v_rcp_f32 v46, v46
    v_cvt_pk_bf16_f32 v44, v44, v44
    v_lshlrev_b32 v44, 16, v44
    v_sub_f32 v4, v4, v44
    v_sub_f32 v6, v6, v44
    v_cvt_pk_bf16_f32 v47, v4, v6
    v_lshlrev_b32 v4, 16, v47
    v_and_b32 v6, 0xffff0000, v47
    v_mul_f32 v4, v4, v46
    v_mul_f32 v6, v6, v46
    v_cvt_pk_bf16_f32 v47, v4, v6
    v_lshlrev_b32 v4, 16, v47
    v_and_b32 v6, 0xffff0000, v47
    v_sub_f32 v8, v8, v44
    v_sub_f32 v10, v10, v44
    v_cvt_pk_bf16_f32 v47, v8, v10
    v_lshlrev_b32 v8, 16, v47
    v_and_b32 v10, 0xffff0000, v47
    v_mul_f32 v8, v8, v46
    v_mul_f32 v10, v10, v46
    v_cvt_pk_bf16_f32 v47, v8, v10
    v_lshlrev_b32 v8, 16, v47
    v_and_b32 v10, 0xffff0000, v47
    v_sub_f32 v12, v12, v44
    v_sub_f32 v14, v14, v44
    v_cvt_pk_bf16_f32 v47, v12, v14
    v_lshlrev_b32 v12, 16, v47
    v_and_b32 v14, 0xffff0000, v47
    v_mul_f32 v12, v12, v46
    v_mul_f32 v14, v14, v46
    v_cvt_pk_bf16_f32 v47, v12, v14
    v_lshlrev_b32 v12, 16, v47
    v_and_b32 v14, 0xffff0000, v47
    v_sub_f32 v16, v16, v44
    v_sub_f32 v18, v18, v44
    v_cvt_pk_bf16_f32 v47, v16, v18
    v_lshlrev_b32 v16, 16, v47
    v_and_b32 v18, 0xffff0000, v47
    v_mul_f32 v16, v16, v46
    v_mul_f32 v18, v18, v46
    v_cvt_pk_bf16_f32 v47, v16, v18
    v_lshlrev_b32 v16, 16, v47
    v_and_b32 v18, 0xffff0000, v47
    v_sub_f32 v20, v20, v44
    v_sub_f32 v22, v22, v44
    v_cvt_pk_bf16_f32 v47, v20, v22
    v_lshlrev_b32 v20, 16, v47
    v_and_b32 v22, 0xffff0000, v47
    v_mul_f32 v20, v20, v46
    v_mul_f32 v22, v22, v46
    v_cvt_pk_bf16_f32 v47, v20, v22
    v_lshlrev_b32 v20, 16, v47
    v_and_b32 v22, 0xffff0000, v47
    v_mul_f32 v29, s66, v45
    v_fma_f32 v44, -v29, s67, v45
    v_fma_f32 v29, v44, s66, v29
    v_cvt_pk_bf16_f32 v29, v29, v29
    v_lshlrev_b32 v29, 16, v29
    v_add_f32 v29, 0x3727c5ac, v29
    v_cvt_pk_bf16_f32 v29, v29, v29
    v_lshlrev_b32 v29, 16, v29
    v_sqrt_f32 v29, v29
    s_nop 0
    v_cvt_pk_bf16_f32 v29, v29, v29
    v_lshlrev_b32 v29, 16, v29
    v_rcp_f32 v29, v29
    v_cvt_pk_bf16_f32 v28, v28, v28
    v_lshlrev_b32 v28, 16, v28
    v_sub_f32 v5, v5, v28
    v_sub_f32 v7, v7, v28
    v_cvt_pk_bf16_f32 v44, v5, v7
    v_lshlrev_b32 v5, 16, v44
    v_and_b32 v7, 0xffff0000, v44
    v_mul_f32 v5, v5, v29
    v_mul_f32 v7, v7, v29
    v_cvt_pk_bf16_f32 v44, v5, v7
    v_lshlrev_b32 v5, 16, v44
    v_and_b32 v7, 0xffff0000, v44
    v_sub_f32 v9, v9, v28
    v_sub_f32 v11, v11, v28
    v_cvt_pk_bf16_f32 v44, v9, v11
    v_lshlrev_b32 v9, 16, v44
    v_and_b32 v11, 0xffff0000, v44
    v_mul_f32 v9, v9, v29
    v_mul_f32 v11, v11, v29
    v_cvt_pk_bf16_f32 v44, v9, v11
    v_lshlrev_b32 v9, 16, v44
    v_and_b32 v11, 0xffff0000, v44
    v_sub_f32 v13, v13, v28
    v_sub_f32 v15, v15, v28
    v_cvt_pk_bf16_f32 v44, v13, v15
    v_lshlrev_b32 v13, 16, v44
    v_and_b32 v15, 0xffff0000, v44
    v_mul_f32 v13, v13, v29
    v_mul_f32 v15, v15, v29
    v_cvt_pk_bf16_f32 v44, v13, v15
    v_lshlrev_b32 v13, 16, v44
    v_and_b32 v15, 0xffff0000, v44
    v_sub_f32 v17, v17, v28
    v_sub_f32 v19, v19, v28
    v_cvt_pk_bf16_f32 v44, v17, v19
    v_lshlrev_b32 v17, 16, v44
    v_and_b32 v19, 0xffff0000, v44
    v_mul_f32 v17, v17, v29
    v_mul_f32 v19, v19, v29
    v_cvt_pk_bf16_f32 v44, v17, v19
    v_lshlrev_b32 v17, 16, v44
    v_and_b32 v19, 0xffff0000, v44
    v_sub_f32 v21, v21, v28
    v_sub_f32 v23, v23, v28
    v_cvt_pk_bf16_f32 v44, v21, v23
    v_lshlrev_b32 v21, 16, v44
    v_and_b32 v23, 0xffff0000, v44
    v_mul_f32 v21, v21, v29
    v_mul_f32 v23, v23, v29
    v_cvt_pk_bf16_f32 v44, v21, v23
    v_lshlrev_b32 v21, 16, v44
    v_and_b32 v23, 0xffff0000, v44
    v_perm_b32 v64, v6, v4, s68
    v_perm_b32 v72, v7, v5, s68
    v_perm_b32 v65, v10, v8, s68
    v_perm_b32 v73, v11, v9, s68
    v_perm_b32 v66, v14, v12, s68
    v_perm_b32 v74, v15, v13, s68
    v_perm_b32 v67, v18, v16, s68
    v_perm_b32 v75, v19, v17, s68
    v_perm_b32 v68, v22, v20, s68
    v_perm_b32 v69, v23, v21, s68
    s_add_u32 s6, s5, 11534336
    buffer_store_dwordx4 v[64:67], v31, s[40:43], s6 offen
    buffer_store_dword v68, v31, s[40:43], s6 offen offset:16
    buffer_store_dwordx4 v[72:75], v31, s[40:43], s6 offen offset:1280
    buffer_store_dword v69, v31, s[40:43], s6 offen offset:1296
    s_waitcnt vmcnt(0)
.Lk3_end:
    s_endpgm

.globl k4_gemm1_kernel
.p2align 8
.type k4_gemm1_kernel,@function
k4_gemm1_kernel:
    s_cmp_ge_u32 s2, 256
    s_cbranch_scc1 .Lk4_end
    s_load_dwordx4 s[16:19], s[0:1], 32
    s_load_dwordx2 s[20:21], s[0:1], 64
    s_load_dwordx2 s[24:25], s[0:1], 80
    v_lshrrev_b32 v1, 6, v0
    s_nop 0
    v_readfirstlane_b32 s3, v1
    s_and_b32 s4, s2, 7
    s_lshr_b32 s5, s2, 3
    s_lshl_b32 s6, s4, 1
    s_lshr_b32 s7, s5, 4
    s_add_u32 s6, s6, s7
    s_and_b32 s7, s5, 15
    s_mul_i32 s6, s6, 128
    s_mul_i32 s7, s7, 96
    v_and_b32 v3, 63, v0
    s_waitcnt lgkmcnt(0)
    s_mov_b32 s40, s24
    s_and_b32 s41, s25, 0xffff
    s_mov_b32 s42, 0x2000000
    s_mov_b32 s43, 0x00020000
    s_mov_b32 s36, s18
    s_and_b32 s37, s19, 0xffff
    s_mov_b32 s38, 0xc00
    s_mov_b32 s39, 0x00020000
    s_mov_b32 s32, s20
    s_and_b32 s33, s21, 0xffff
    s_mov_b32 s34, 0x280000
    s_mov_b32 s35, 0x00020000
    v_add_u32 v4, 0, v0
    v_mul_u32_u24 v204, 43691, v4
    v_lshrrev_b32 v204, 19, v204
    v_mul_u32_u24 v200, 12, v204
    v_sub_u32 v4, v4, v200
    v_mul_u32_u24 v200, 400, v204
    v_lshl_add_u32 v200, v4, 5, v200
    v_add_u32 v204, s6, v204
    v_mul_u32_u24 v204, 3328, v204
    v_lshl_add_u32 v4, v4, 3, s7
    v_lshlrev_b32 v4, 1, v4
    v_add_u32 v204, v204, v4
    buffer_load_dwordx4 v[208:211], v4, s[36:39], 0 offen
    v_add_u32 v4, 512, v0
    v_mul_u32_u24 v205, 43691, v4
    v_lshrrev_b32 v205, 19, v205
    v_mul_u32_u24 v201, 12, v205
    v_sub_u32 v4, v4, v201
    v_mul_u32_u24 v201, 400, v205
    v_lshl_add_u32 v201, v4, 5, v201
    v_add_u32 v205, s6, v205
    v_mul_u32_u24 v205, 3328, v205
    v_lshl_add_u32 v4, v4, 3, s7
    v_lshlrev_b32 v4, 1, v4
    v_add_u32 v205, v205, v4
    buffer_load_dwordx4 v[212:215], v4, s[36:39], 0 offen
    v_add_u32 v4, 1024, v0
    v_mul_u32_u24 v206, 43691, v4
    v_lshrrev_b32 v206, 19, v206
    v_mul_u32_u24 v202, 12, v206
    v_sub_u32 v4, v4, v202
    v_mul_u32_u24 v202, 400, v206
    v_lshl_add_u32 v202, v4, 5, v202
    v_add_u32 v206, s6, v206
    v_mul_u32_u24 v206, 3328, v206
    v_lshl_add_u32 v4, v4, 3, s7
    v_lshlrev_b32 v4, 1, v4
    v_add_u32 v206, v206, v4
    buffer_load_dwordx4 v[216:219], v4, s[36:39], 0 offen
    s_cmp_lt_u32 s3, 4
    s_cbranch_scc1 .Lk4_cons
    s_mov_b32 s44, s16
    s_and_b32 s45, s17, 0xffff
    s_mov_b32 s46, 0x1e0000
    s_mov_b32 s47, 0x00020000
    s_sub_u32 s3, s3, 4
    v_lshrrev_b32 v4, 3, v3
    v_and_b32 v5, 7, v3
    v_xor_b32 v5, v5, v4
    v_lshlrev_b32 v5, 4, v5
    v_mul_u32_u24 v4, 1280, v4
    v_add_u32 v5, v5, v4
    v_add_u32 v4, 0, v3
    v_mul_u32_u24 v9, 43691, v4
    v_lshrrev_b32 v9, 19, v9
    v_mul_u32_u24 v6, 12, v9
    v_sub_u32 v4, v4, v6
    v_mul_u32_u24 v9, 3072, v9
    v_lshl_add_u32 v6, v4, 4, v9
    v_add_u32 v4, 64, v3
    v_mul_u32_u24 v9, 43691, v4
    v_lshrrev_b32 v9, 19, v9
    v_mul_u32_u24 v7, 12, v9
    v_sub_u32 v4, v4, v7
    v_mul_u32_u24 v9, 3072, v9
    v_lshl_add_u32 v7, v4, 4, v9
    v_add_u32 v4, 128, v3
    v_mul_u32_u24 v9, 43691, v4
    v_lshrrev_b32 v9, 19, v9
    v_mul_u32_u24 v8, 12, v9
    v_sub_u32 v4, v4, v8
    v_mul_u32_u24 v9, 3072, v9
    v_lshl_add_u32 v8, v4, 4, v9
    s_add_u32 s8, s3, 0
    s_mov_b32 s10, s8
    s_mov_b32 s9, 0
    s_mov_b32 s11, 0
    s_lshl_b32 s12, s10, 10
    s_add_u32 s64, s12, s11
    s_lshl_b32 s10, s10, 3
    s_add_u32 s10, s10, s6
    s_mul_i32 s10, s10, 1280
    s_add_u32 s10, s10, 11534336
    s_add_u32 s48, s10, s9
    s_add_u32 s8, s3, 4
    s_mov_b32 s10, s8
    s_mov_b32 s9, 0
    s_mov_b32 s11, 0
    s_lshl_b32 s12, s10, 10
    s_add_u32 s65, s12, s11
    s_lshl_b32 s10, s10, 3
    s_add_u32 s10, s10, s6
    s_mul_i32 s10, s10, 1280
    s_add_u32 s10, s10, 11534336
    s_add_u32 s49, s10, s9
    s_add_u32 s8, s3, 8
    s_mov_b32 s10, s8
    s_mov_b32 s9, 0
    s_mov_b32 s11, 0
    s_lshl_b32 s12, s10, 10
    s_add_u32 s66, s12, s11
    s_lshl_b32 s10, s10, 3
    s_add_u32 s10, s10, s6
    s_mul_i32 s10, s10, 1280
    s_add_u32 s10, s10, 11534336
    s_add_u32 s50, s10, s9
    s_add_u32 s8, s3, 12
    s_mov_b32 s10, s8
    s_mov_b32 s9, 0
    s_mov_b32 s11, 0
    s_lshl_b32 s12, s10, 10
    s_add_u32 s67, s12, s11
    s_lshl_b32 s10, s10, 3
    s_add_u32 s10, s10, s6
    s_mul_i32 s10, s10, 1280
    s_add_u32 s10, s10, 11534336
    s_add_u32 s51, s10, s9
    s_mul_i32 s10, s3, 49152
    s_lshl_b32 s11, s7, 1
    s_add_u32 s56, s10, s11
    s_mul_i32 s57, s3, 3072
    s_add_u32 s57, s57, 16384
    s_add_u32 m0, s64, 0
    s_add_u32 s8, s48, 0
    buffer_load_dwordx4 v5, s[40:43], s8 offen lds
    s_add_u32 m0, s65, 0
    s_add_u32 s8, s49, 0
    buffer_load_dwordx4 v5, s[40:43], s8 offen lds
    s_add_u32 m0, s66, 0
    s_add_u32 s8, s50, 0
    buffer_load_dwordx4 v5, s[40:43], s8 offen lds
    s_add_u32 m0, s67, 0
    s_add_u32 s8, s51, 0
    buffer_load_dwordx4 v5, s[40:43], s8 offen lds
    s_add_u32 s8, s56, 0
    s_add_u32 m0, s57, 0
    s_nop 0
    buffer_load_dwordx4 v6, s[44:47], s8 offen lds
    s_add_u32 m0, s57, 1024
    s_nop 0
    buffer_load_dwordx4 v7, s[44:47], s8 offen lds
    s_add_u32 m0, s57, 2048
    s_nop 0
    buffer_load_dwordx4 v8, s[44:47], s8 offen lds
    s_add_u32 m0, s64, 28672
    s_add_u32 s8, s48, 128
    buffer_load_dwordx4 v5, s[40:43], s8 offen lds
    s_add_u32 m0, s65, 28672
    s_add_u32 s8, s49, 128
    buffer_load_dwordx4 v5, s[40:43], s8 offen lds
    s_add_u32 m0, s66, 28672
    s_add_u32 s8, s50, 128
    buffer_load_dwordx4 v5, s[40:43], s8 offen lds
    s_add_u32 m0, s67, 28672
    s_add_u32 s8, s51, 128
    buffer_load_dwordx4 v5, s[40:43], s8 offen lds
    s_add_u32 s8, s56, 196608
    s_add_u32 m0, s57, 28672
    s_nop 0
    buffer_load_dwordx4 v6, s[44:47], s8 offen lds
    s_add_u32 m0, s57, 29696
    s_nop 0
    buffer_load_dwordx4 v7, s[44:47], s8 offen lds
    s_add_u32 m0, s57, 30720
    s_nop 0
    buffer_load_dwordx4 v8, s[44:47], s8 offen lds
    s_waitcnt vmcnt(7)
    s_barrier
    s_add_u32 m0, s64, 57344
    s_add_u32 s8, s48, 256
    buffer_load_dwordx4 v5, s[40:43], s8 offen lds
    s_add_u32 m0, s65, 57344
    s_add_u32 s8, s49, 256
    buffer_load_dwordx4 v5, s[40:43], s8 offen lds
    s_add_u32 m0, s66, 57344
    s_add_u32 s8, s50, 256
    buffer_load_dwordx4 v5, s[40:43], s8 offen lds
    s_add_u32 m0, s67, 57344
    s_add_u32 s8, s51, 256
    buffer_load_dwordx4 v5, s[40:43], s8 offen lds
    s_add_u32 s8, s56, 393216
    s_add_u32 m0, s57, 57344
    s_nop 0
    buffer_load_dwordx4 v6, s[44:47], s8 offen lds
    s_add_u32 m0, s57, 58368
    s_nop 0
    buffer_load_dwordx4 v7, s[44:47], s8 offen lds
    s_add_u32 m0, s57, 59392
    s_nop 0
    buffer_load_dwordx4 v8, s[44:47], s8 offen lds
    s_add_u32 m0, s64, 86016
    s_add_u32 s8, s48, 384
    buffer_load_dwordx4 v5, s[40:43], s8 offen lds
    s_add_u32 m0, s65, 86016
    s_add_u32 s8, s49, 384
    buffer_load_dwordx4 v5, s[40:43], s8 offen lds
    s_add_u32 m0, s66, 86016
    s_add_u32 s8, s50, 384
    buffer_load_dwordx4 v5, s[40:43], s8 offen lds
    s_add_u32 m0, s67, 86016
    s_add_u32 s8, s51, 384
    buffer_load_dwordx4 v5, s[40:43], s8 offen lds
    s_add_u32 s8, s56, 589824
    s_add_u32 m0, s57, 86016
    s_nop 0
    buffer_load_dwordx4 v6, s[44:47], s8 offen lds
    s_add_u32 m0, s57, 87040
    s_nop 0
    buffer_load_dwordx4 v7, s[44:47], s8 offen lds
    s_add_u32 m0, s57, 88064
    s_nop 0
    buffer_load_dwordx4 v8, s[44:47], s8 offen lds
    s_waitcnt vmcnt(14)
    s_barrier
    s_add_u32 m0, s64, 114688
    s_add_u32 s8, s48, 512
    buffer_load_dwordx4 v5, s[40:43], s8 offen lds
    s_add_u32 m0, s65, 114688
    s_add_u32 s8, s49, 512
    buffer_load_dwordx4 v5, s[40:43], s8 offen lds
    s_add_u32 m0, s66, 114688
    s_add_u32 s8, s50, 512
    buffer_load_dwordx4 v5, s[40:43], s8 offen lds
    s_add_u32 m0, s67, 114688
    s_add_u32 s8, s51, 512
    buffer_load_dwordx4 v5, s[40:43], s8 offen lds
    s_add_u32 s8, s56, 786432
    s_add_u32 m0, s57, 114688
    s_nop 0
    buffer_load_dwordx4 v6, s[44:47], s8 offen lds
    s_add_u32 m0, s57, 115712
    s_nop 0
    buffer_load_dwordx4 v7, s[44:47], s8 offen lds
    s_add_u32 m0, s57, 116736
    s_nop 0
    buffer_load_dwordx4 v8, s[44:47], s8 offen lds
    s_add_u32 m0, s64, 0
    s_add_u32 s8, s48, 640
    buffer_load_dwordx4 v5, s[40:43], s8 offen lds
    s_add_u32 m0, s65, 0
    s_add_u32 s8, s49, 640
    buffer_load_dwordx4 v5, s[40:43], s8 offen lds
    s_add_u32 m0, s66, 0
    s_add_u32 s8, s50, 640
    buffer_load_dwordx4 v5, s[40:43], s8 offen lds
    s_add_u32 m0, s67, 0
    s_add_u32 s8, s51, 640
    buffer_load_dwordx4 v5, s[40:43], s8 offen lds
    s_add_u32 s8, s56, 983040
    s_add_u32 m0, s57, 0
    s_nop 0
    buffer_load_dwordx4 v6, s[44:47], s8 offen lds
    s_add_u32 m0, s57, 1024
    s_nop 0
    buffer_load_dwordx4 v7, s[44:47], s8 offen lds
    s_add_u32 m0, s57, 2048
    s_nop 0
    buffer_load_dwordx4 v8, s[44:47], s8 offen lds
    s_waitcnt vmcnt(21)
    s_barrier
    s_add_u32 m0, s64, 28672
    s_add_u32 s8, s48, 768
    buffer_load_dwordx4 v5, s[40:43], s8 offen lds
    s_add_u32 m0, s65, 28672
    s_add_u32 s8, s49, 768
    buffer_load_dwordx4 v5, s[40:43], s8 offen lds
    s_add_u32 m0, s66, 28672
    s_add_u32 s8, s50, 768
    buffer_load_dwordx4 v5, s[40:43], s8 offen lds
    s_add_u32 m0, s67, 28672
    s_add_u32 s8, s51, 768
    buffer_load_dwordx4 v5, s[40:43], s8 offen lds
    s_add_u32 s8, s56, 1179648
    s_add_u32 m0, s57, 28672
    s_nop 0
    buffer_load_dwordx4 v6, s[44:47], s8 offen lds
    s_add_u32 m0, s57, 29696
    s_nop 0
    buffer_load_dwordx4 v7, s[44:47], s8 offen lds
    s_add_u32 m0, s57, 30720
    s_nop 0
    buffer_load_dwordx4 v8, s[44:47], s8 offen lds
    s_waitcnt vmcnt(21)
    s_barrier
    s_add_u32 m0, s64, 57344
    s_add_u32 s8, s48, 896
    buffer_load_dwordx4 v5, s[40:43], s8 offen lds
    s_add_u32 m0, s65, 57344
    s_add_u32 s8, s49, 896
    buffer_load_dwordx4 v5, s[40:43], s8 offen lds
    s_add_u32 m0, s66, 57344
    s_add_u32 s8, s50, 896
    buffer_load_dwordx4 v5, s[40:43], s8 offen lds
    s_add_u32 m0, s67, 57344
    s_add_u32 s8, s51, 896
    buffer_load_dwordx4 v5, s[40:43], s8 offen lds
    s_add_u32 s8, s56, 1376256
    s_add_u32 m0, s57, 57344
    s_nop 0
    buffer_load_dwordx4 v6, s[44:47], s8 offen lds
    s_add_u32 m0, s57, 58368
    s_nop 0
    buffer_load_dwordx4 v7, s[44:47], s8 offen lds
    s_add_u32 m0, s57, 59392
    s_nop 0
    buffer_load_dwordx4 v8, s[44:47], s8 offen lds
    s_waitcnt vmcnt(21)
    s_barrier
    s_add_u32 m0, s64, 86016
    s_add_u32 s8, s48, 1024
    buffer_load_dwordx4 v5, s[40:43], s8 offen lds
    s_add_u32 m0, s65, 86016
    s_add_u32 s8, s49, 1024
    buffer_load_dwordx4 v5, s[40:43], s8 offen lds
    s_add_u32 m0, s66, 86016
    s_add_u32 s8, s50, 1024
    buffer_load_dwordx4 v5, s[40:43], s8 offen lds
    s_add_u32 m0, s67, 86016
    s_add_u32 s8, s51, 1024
    buffer_load_dwordx4 v5, s[40:43], s8 offen lds
    s_add_u32 s8, s56, 1572864
    s_add_u32 m0, s57, 86016
    s_nop 0
    buffer_load_dwordx4 v6, s[44:47], s8 offen lds
    s_add_u32 m0, s57, 87040
    s_nop 0
    buffer_load_dwordx4 v7, s[44:47], s8 offen lds
    s_add_u32 m0, s57, 88064
    s_nop 0
    buffer_load_dwordx4 v8, s[44:47], s8 offen lds
    s_waitcnt vmcnt(21)
    s_barrier
    s_add_u32 m0, s64, 114688
    s_add_u32 s8, s48, 1152
    buffer_load_dwordx4 v5, s[40:43], s8 offen lds
    s_add_u32 m0, s65, 114688
    s_add_u32 s8, s49, 1152
    buffer_load_dwordx4 v5, s[40:43], s8 offen lds
    s_add_u32 m0, s66, 114688
    s_add_u32 s8, s50, 1152
    buffer_load_dwordx4 v5, s[40:43], s8 offen lds
    s_add_u32 m0, s67, 114688
    s_add_u32 s8, s51, 1152
    buffer_load_dwordx4 v5, s[40:43], s8 offen lds
    s_add_u32 s8, s56, 1769472
    s_add_u32 m0, s57, 114688
    s_nop 0
    buffer_load_dwordx4 v6, s[44:47], s8 offen lds
    s_add_u32 m0, s57, 115712
    s_nop 0
    buffer_load_dwordx4 v7, s[44:47], s8 offen lds
    s_add_u32 m0, s57, 116736
    s_nop 0
    buffer_load_dwordx4 v8, s[44:47], s8 offen lds
    s_waitcnt vmcnt(21)
    s_barrier
    s_waitcnt vmcnt(14)
    s_barrier
    s_waitcnt vmcnt(7)
    s_barrier
    s_waitcnt vmcnt(0)
    s_barrier
    s_barrier
    s_branch .Lk4_epi
.Lk4_cons:
    v_lshrrev_b32 v10, 4, v3
    s_lshr_b32 s8, s3, 1
    s_lshl_b32 s8, s8, 6
    s_mul_i32 s8, s8, 400
    s_and_b32 s9, s3, 1
    s_mul_i32 s9, s9, 192
    s_add_u32 s8, s8, s9
    v_and_b32 v11, 15, v3
    v_mul_u32_u24 v11, 400, v11
    v_lshl_add_u32 v11, v10, 4, v11
    v_add_u32 v11, s8, v11
    v_and_b32 v4, 7, v3
    v_xor_b32 v4, v4, v10
    v_lshlrev_b32 v4, 4, v4
    v_and_b32 v12, 15, v3
    v_lshl_add_u32 v12, v12, 7, v4
    v_and_b32 v4, 15, v3
    v_lshrrev_b32 v13, 2, v4
    v_lshl_add_u32 v13, v10, 3, v13
    v_mul_u32_u24 v13, 192, v13
    v_and_b32 v4, 3, v4
    v_lshl_add_u32 v13, v4, 3, v13
    s_lshr_b32 s8, s3, 1
    s_mul_i32 s8, s8, 8192
    s_and_b32 s9, s3, 1
    s_mul_i32 s9, s9, 96
    s_add_u32 s9, s9, 16384
    v_add_u32 v13, s9, v13
    v_add_u32 v12, s8, v12
    v_mov_b32 v16, 0
    v_mov_b32 v17, 0
    v_mov_b32 v18, 0
    v_mov_b32 v19, 0
    v_mov_b32 v20, 0
    v_mov_b32 v21, 0
    v_mov_b32 v22, 0
    v_mov_b32 v23, 0
    v_mov_b32 v24, 0
    v_mov_b32 v25, 0
    v_mov_b32 v26, 0
    v_mov_b32 v27, 0
    v_mov_b32 v28, 0
    v_mov_b32 v29, 0
    v_mov_b32 v30, 0
    v_mov_b32 v31, 0
    v_mov_b32 v32, 0
    v_mov_b32 v33, 0
    v_mov_b32 v34, 0
    v_mov_b32 v35, 0
    v_mov_b32 v36, 0
    v_mov_b32 v37, 0
    v_mov_b32 v38, 0
    v_mov_b32 v39, 0
    v_mov_b32 v40, 0
    v_mov_b32 v41, 0
    v_mov_b32 v42, 0
    v_mov_b32 v43, 0
    v_mov_b32 v44, 0
    v_mov_b32 v45, 0
    v_mov_b32 v46, 0
    v_mov_b32 v47, 0
    v_mov_b32 v48, 0
    v_mov_b32 v49, 0
    v_mov_b32 v50, 0
    v_mov_b32 v51, 0
    v_mov_b32 v52, 0
    v_mov_b32 v53, 0
    v_mov_b32 v54, 0
    v_mov_b32 v55, 0
    v_mov_b32 v56, 0
    v_mov_b32 v57, 0
    v_mov_b32 v58, 0
    v_mov_b32 v59, 0
    v_mov_b32 v60, 0
    v_mov_b32 v61, 0
    v_mov_b32 v62, 0
    v_mov_b32 v63, 0
    s_barrier
    v_add_u32 v14, 0, v12
    v_add_u32 v15, 0, v13
    ds_read_b128 v[64:67], v14 offset:0
    ds_read_b128 v[68:71], v14 offset:2048
    ds_read_b128 v[72:75], v14 offset:4096
    ds_read_b128 v[76:79], v14 offset:6144
    ds_read_b64_tr_b16 v[80:81], v15 offset:0
    ds_read_b64_tr_b16 v[82:83], v15 offset:768
    ds_read_b64_tr_b16 v[84:85], v15 offset:32
    ds_read_b64_tr_b16 v[86:87], v15 offset:800
    ds_read_b64_tr_b16 v[88:89], v15 offset:64
    ds_read_b64_tr_b16 v[90:91], v15 offset:832
    v_xor_b32 v14, 64, v14
    ds_read_b128 v[92:95], v14 offset:0
    ds_read_b128 v[96:99], v14 offset:2048
    ds_read_b128 v[100:103], v14 offset:4096
    ds_read_b128 v[104:107], v14 offset:6144
    ds_read_b64_tr_b16 v[108:109], v15 offset:6144
    ds_read_b64_tr_b16 v[110:111], v15 offset:6912
    ds_read_b64_tr_b16 v[112:113], v15 offset:6176
    ds_read_b64_tr_b16 v[114:115], v15 offset:6944
    ds_read_b64_tr_b16 v[116:117], v15 offset:6208
    ds_read_b64_tr_b16 v[118:119], v15 offset:6976
    s_waitcnt lgkmcnt(0)
    s_barrier
    v_add_u32 v14, 28672, v12
    v_add_u32 v15, 28672, v13
    ds_read_b128 v[120:123], v14 offset:0
    ds_read_b128 v[124:127], v14 offset:2048
    ds_read_b128 v[128:131], v14 offset:4096
    ds_read_b128 v[132:135], v14 offset:6144
    ds_read_b64_tr_b16 v[136:137], v15 offset:0
    ds_read_b64_tr_b16 v[138:139], v15 offset:768
    ds_read_b64_tr_b16 v[140:141], v15 offset:32
    ds_read_b64_tr_b16 v[142:143], v15 offset:800
    ds_read_b64_tr_b16 v[144:145], v15 offset:64
    ds_read_b64_tr_b16 v[146:147], v15 offset:832
    v_xor_b32 v14, 64, v14
    ds_read_b128 v[148:151], v14 offset:0
    ds_read_b128 v[152:155], v14 offset:2048
    ds_read_b128 v[156:159], v14 offset:4096
    ds_read_b128 v[160:163], v14 offset:6144
    ds_read_b64_tr_b16 v[164:165], v15 offset:6144
    ds_read_b64_tr_b16 v[166:167], v15 offset:6912
    ds_read_b64_tr_b16 v[168:169], v15 offset:6176
    ds_read_b64_tr_b16 v[170:171], v15 offset:6944
    ds_read_b64_tr_b16 v[172:173], v15 offset:6208
    ds_read_b64_tr_b16 v[174:175], v15 offset:6976
    v_mfma_f32_16x16x32_bf16 v[16:19], v[80:83], v[64:67], v[16:19]
    v_mfma_f32_16x16x32_bf16 v[20:23], v[80:83], v[68:71], v[20:23]
    v_mfma_f32_16x16x32_bf16 v[24:27], v[80:83], v[72:75], v[24:27]
    v_mfma_f32_16x16x32_bf16 v[28:31], v[80:83], v[76:79], v[28:31]
    v_mfma_f32_16x16x32_bf16 v[32:35], v[84:87], v[64:67], v[32:35]
    v_mfma_f32_16x16x32_bf16 v[36:39], v[84:87], v[68:71], v[36:39]
    v_mfma_f32_16x16x32_bf16 v[40:43], v[84:87], v[72:75], v[40:43]
    v_mfma_f32_16x16x32_bf16 v[44:47], v[84:87], v[76:79], v[44:47]
    v_mfma_f32_16x16x32_bf16 v[48:51], v[88:91], v[64:67], v[48:51]
    v_mfma_f32_16x16x32_bf16 v[52:55], v[88:91], v[68:71], v[52:55]
    v_mfma_f32_16x16x32_bf16 v[56:59], v[88:91], v[72:75], v[56:59]
    v_mfma_f32_16x16x32_bf16 v[60:63], v[88:91], v[76:79], v[60:63]
    v_mfma_f32_16x16x32_bf16 v[16:19], v[108:111], v[92:95], v[16:19]
    v_mfma_f32_16x16x32_bf16 v[20:23], v[108:111], v[96:99], v[20:23]
    v_mfma_f32_16x16x32_bf16 v[24:27], v[108:111], v[100:103], v[24:27]
    v_mfma_f32_16x16x32_bf16 v[28:31], v[108:111], v[104:107], v[28:31]
    v_mfma_f32_16x16x32_bf16 v[32:35], v[112:115], v[92:95], v[32:35]
    v_mfma_f32_16x16x32_bf16 v[36:39], v[112:115], v[96:99], v[36:39]
    v_mfma_f32_16x16x32_bf16 v[40:43], v[112:115], v[100:103], v[40:43]
    v_mfma_f32_16x16x32_bf16 v[44:47], v[112:115], v[104:107], v[44:47]
    v_mfma_f32_16x16x32_bf16 v[48:51], v[116:119], v[92:95], v[48:51]
    v_mfma_f32_16x16x32_bf16 v[52:55], v[116:119], v[96:99], v[52:55]
    v_mfma_f32_16x16x32_bf16 v[56:59], v[116:119], v[100:103], v[56:59]
    v_mfma_f32_16x16x32_bf16 v[60:63], v[116:119], v[104:107], v[60:63]
    s_waitcnt lgkmcnt(0)
    s_barrier
    v_add_u32 v14, 57344, v12
    v_add_u32 v15, 57344, v13
    ds_read_b128 v[64:67], v14 offset:0
    ds_read_b128 v[68:71], v14 offset:2048
    ds_read_b128 v[72:75], v14 offset:4096
    ds_read_b128 v[76:79], v14 offset:6144
    ds_read_b64_tr_b16 v[80:81], v15 offset:0
    ds_read_b64_tr_b16 v[82:83], v15 offset:768
    ds_read_b64_tr_b16 v[84:85], v15 offset:32
    ds_read_b64_tr_b16 v[86:87], v15 offset:800
    ds_read_b64_tr_b16 v[88:89], v15 offset:64
    ds_read_b64_tr_b16 v[90:91], v15 offset:832
    v_xor_b32 v14, 64, v14
    ds_read_b128 v[92:95], v14 offset:0
    ds_read_b128 v[96:99], v14 offset:2048
    ds_read_b128 v[100:103], v14 offset:4096
    ds_read_b128 v[104:107], v14 offset:6144
    ds_read_b64_tr_b16 v[108:109], v15 offset:6144
    ds_read_b64_tr_b16 v[110:111], v15 offset:6912
    ds_read_b64_tr_b16 v[112:113], v15 offset:6176
    ds_read_b64_tr_b16 v[114:115], v15 offset:6944
    ds_read_b64_tr_b16 v[116:117], v15 offset:6208
    ds_read_b64_tr_b16 v[118:119], v15 offset:6976
    v_mfma_f32_16x16x32_bf16 v[16:19], v[136:139], v[120:123], v[16:19]
    v_mfma_f32_16x16x32_bf16 v[20:23], v[136:139], v[124:127], v[20:23]
    v_mfma_f32_16x16x32_bf16 v[24:27], v[136:139], v[128:131], v[24:27]
    v_mfma_f32_16x16x32_bf16 v[28:31], v[136:139], v[132:135], v[28:31]
    v_mfma_f32_16x16x32_bf16 v[32:35], v[140:143], v[120:123], v[32:35]
    v_mfma_f32_16x16x32_bf16 v[36:39], v[140:143], v[124:127], v[36:39]
    v_mfma_f32_16x16x32_bf16 v[40:43], v[140:143], v[128:131], v[40:43]
    v_mfma_f32_16x16x32_bf16 v[44:47], v[140:143], v[132:135], v[44:47]
    v_mfma_f32_16x16x32_bf16 v[48:51], v[144:147], v[120:123], v[48:51]
    v_mfma_f32_16x16x32_bf16 v[52:55], v[144:147], v[124:127], v[52:55]
    v_mfma_f32_16x16x32_bf16 v[56:59], v[144:147], v[128:131], v[56:59]
    v_mfma_f32_16x16x32_bf16 v[60:63], v[144:147], v[132:135], v[60:63]
    v_mfma_f32_16x16x32_bf16 v[16:19], v[164:167], v[148:151], v[16:19]
    v_mfma_f32_16x16x32_bf16 v[20:23], v[164:167], v[152:155], v[20:23]
    v_mfma_f32_16x16x32_bf16 v[24:27], v[164:167], v[156:159], v[24:27]
    v_mfma_f32_16x16x32_bf16 v[28:31], v[164:167], v[160:163], v[28:31]
    v_mfma_f32_16x16x32_bf16 v[32:35], v[168:171], v[148:151], v[32:35]
    v_mfma_f32_16x16x32_bf16 v[36:39], v[168:171], v[152:155], v[36:39]
    v_mfma_f32_16x16x32_bf16 v[40:43], v[168:171], v[156:159], v[40:43]
    v_mfma_f32_16x16x32_bf16 v[44:47], v[168:171], v[160:163], v[44:47]
    v_mfma_f32_16x16x32_bf16 v[48:51], v[172:175], v[148:151], v[48:51]
    v_mfma_f32_16x16x32_bf16 v[52:55], v[172:175], v[152:155], v[52:55]
    v_mfma_f32_16x16x32_bf16 v[56:59], v[172:175], v[156:159], v[56:59]
    v_mfma_f32_16x16x32_bf16 v[60:63], v[172:175], v[160:163], v[60:63]
    s_waitcnt lgkmcnt(0)
    s_barrier
    v_add_u32 v14, 86016, v12
    v_add_u32 v15, 86016, v13
    ds_read_b128 v[120:123], v14 offset:0
    ds_read_b128 v[124:127], v14 offset:2048
    ds_read_b128 v[128:131], v14 offset:4096
    ds_read_b128 v[132:135], v14 offset:6144
    ds_read_b64_tr_b16 v[136:137], v15 offset:0
    ds_read_b64_tr_b16 v[138:139], v15 offset:768
    ds_read_b64_tr_b16 v[140:141], v15 offset:32
    ds_read_b64_tr_b16 v[142:143], v15 offset:800
    ds_read_b64_tr_b16 v[144:145], v15 offset:64
    ds_read_b64_tr_b16 v[146:147], v15 offset:832
    v_xor_b32 v14, 64, v14
    ds_read_b128 v[148:151], v14 offset:0
    ds_read_b128 v[152:155], v14 offset:2048
    ds_read_b128 v[156:159], v14 offset:4096
    ds_read_b128 v[160:163], v14 offset:6144
    ds_read_b64_tr_b16 v[164:165], v15 offset:6144
    ds_read_b64_tr_b16 v[166:167], v15 offset:6912
    ds_read_b64_tr_b16 v[168:169], v15 offset:6176
    ds_read_b64_tr_b16 v[170:171], v15 offset:6944
    ds_read_b64_tr_b16 v[172:173], v15 offset:6208
    ds_read_b64_tr_b16 v[174:175], v15 offset:6976
    v_mfma_f32_16x16x32_bf16 v[16:19], v[80:83], v[64:67], v[16:19]
    v_mfma_f32_16x16x32_bf16 v[20:23], v[80:83], v[68:71], v[20:23]
    v_mfma_f32_16x16x32_bf16 v[24:27], v[80:83], v[72:75], v[24:27]
    v_mfma_f32_16x16x32_bf16 v[28:31], v[80:83], v[76:79], v[28:31]
    v_mfma_f32_16x16x32_bf16 v[32:35], v[84:87], v[64:67], v[32:35]
    v_mfma_f32_16x16x32_bf16 v[36:39], v[84:87], v[68:71], v[36:39]
    v_mfma_f32_16x16x32_bf16 v[40:43], v[84:87], v[72:75], v[40:43]
    v_mfma_f32_16x16x32_bf16 v[44:47], v[84:87], v[76:79], v[44:47]
    v_mfma_f32_16x16x32_bf16 v[48:51], v[88:91], v[64:67], v[48:51]
    v_mfma_f32_16x16x32_bf16 v[52:55], v[88:91], v[68:71], v[52:55]
    v_mfma_f32_16x16x32_bf16 v[56:59], v[88:91], v[72:75], v[56:59]
    v_mfma_f32_16x16x32_bf16 v[60:63], v[88:91], v[76:79], v[60:63]
    v_mfma_f32_16x16x32_bf16 v[16:19], v[108:111], v[92:95], v[16:19]
    v_mfma_f32_16x16x32_bf16 v[20:23], v[108:111], v[96:99], v[20:23]
    v_mfma_f32_16x16x32_bf16 v[24:27], v[108:111], v[100:103], v[24:27]
    v_mfma_f32_16x16x32_bf16 v[28:31], v[108:111], v[104:107], v[28:31]
    v_mfma_f32_16x16x32_bf16 v[32:35], v[112:115], v[92:95], v[32:35]
    v_mfma_f32_16x16x32_bf16 v[36:39], v[112:115], v[96:99], v[36:39]
    v_mfma_f32_16x16x32_bf16 v[40:43], v[112:115], v[100:103], v[40:43]
    v_mfma_f32_16x16x32_bf16 v[44:47], v[112:115], v[104:107], v[44:47]
    v_mfma_f32_16x16x32_bf16 v[48:51], v[116:119], v[92:95], v[48:51]
    v_mfma_f32_16x16x32_bf16 v[52:55], v[116:119], v[96:99], v[52:55]
    v_mfma_f32_16x16x32_bf16 v[56:59], v[116:119], v[100:103], v[56:59]
    v_mfma_f32_16x16x32_bf16 v[60:63], v[116:119], v[104:107], v[60:63]
    s_waitcnt lgkmcnt(0)
    s_barrier
    v_add_u32 v14, 114688, v12
    v_add_u32 v15, 114688, v13
    ds_read_b128 v[64:67], v14 offset:0
    ds_read_b128 v[68:71], v14 offset:2048
    ds_read_b128 v[72:75], v14 offset:4096
    ds_read_b128 v[76:79], v14 offset:6144
    ds_read_b64_tr_b16 v[80:81], v15 offset:0
    ds_read_b64_tr_b16 v[82:83], v15 offset:768
    ds_read_b64_tr_b16 v[84:85], v15 offset:32
    ds_read_b64_tr_b16 v[86:87], v15 offset:800
    ds_read_b64_tr_b16 v[88:89], v15 offset:64
    ds_read_b64_tr_b16 v[90:91], v15 offset:832
    v_xor_b32 v14, 64, v14
    ds_read_b128 v[92:95], v14 offset:0
    ds_read_b128 v[96:99], v14 offset:2048
    ds_read_b128 v[100:103], v14 offset:4096
    ds_read_b128 v[104:107], v14 offset:6144
    ds_read_b64_tr_b16 v[108:109], v15 offset:6144
    ds_read_b64_tr_b16 v[110:111], v15 offset:6912
    ds_read_b64_tr_b16 v[112:113], v15 offset:6176
    ds_read_b64_tr_b16 v[114:115], v15 offset:6944
    ds_read_b64_tr_b16 v[116:117], v15 offset:6208
    ds_read_b64_tr_b16 v[118:119], v15 offset:6976
    v_mfma_f32_16x16x32_bf16 v[16:19], v[136:139], v[120:123], v[16:19]
    v_mfma_f32_16x16x32_bf16 v[20:23], v[136:139], v[124:127], v[20:23]
    v_mfma_f32_16x16x32_bf16 v[24:27], v[136:139], v[128:131], v[24:27]
    v_mfma_f32_16x16x32_bf16 v[28:31], v[136:139], v[132:135], v[28:31]
    v_mfma_f32_16x16x32_bf16 v[32:35], v[140:143], v[120:123], v[32:35]
    v_mfma_f32_16x16x32_bf16 v[36:39], v[140:143], v[124:127], v[36:39]
    v_mfma_f32_16x16x32_bf16 v[40:43], v[140:143], v[128:131], v[40:43]
    v_mfma_f32_16x16x32_bf16 v[44:47], v[140:143], v[132:135], v[44:47]
    v_mfma_f32_16x16x32_bf16 v[48:51], v[144:147], v[120:123], v[48:51]
    v_mfma_f32_16x16x32_bf16 v[52:55], v[144:147], v[124:127], v[52:55]
    v_mfma_f32_16x16x32_bf16 v[56:59], v[144:147], v[128:131], v[56:59]
    v_mfma_f32_16x16x32_bf16 v[60:63], v[144:147], v[132:135], v[60:63]
    v_mfma_f32_16x16x32_bf16 v[16:19], v[164:167], v[148:151], v[16:19]
    v_mfma_f32_16x16x32_bf16 v[20:23], v[164:167], v[152:155], v[20:23]
    v_mfma_f32_16x16x32_bf16 v[24:27], v[164:167], v[156:159], v[24:27]
    v_mfma_f32_16x16x32_bf16 v[28:31], v[164:167], v[160:163], v[28:31]
    v_mfma_f32_16x16x32_bf16 v[32:35], v[168:171], v[148:151], v[32:35]
    v_mfma_f32_16x16x32_bf16 v[36:39], v[168:171], v[152:155], v[36:39]
    v_mfma_f32_16x16x32_bf16 v[40:43], v[168:171], v[156:159], v[40:43]
    v_mfma_f32_16x16x32_bf16 v[44:47], v[168:171], v[160:163], v[44:47]
    v_mfma_f32_16x16x32_bf16 v[48:51], v[172:175], v[148:151], v[48:51]
    v_mfma_f32_16x16x32_bf16 v[52:55], v[172:175], v[152:155], v[52:55]
    v_mfma_f32_16x16x32_bf16 v[56:59], v[172:175], v[156:159], v[56:59]
    v_mfma_f32_16x16x32_bf16 v[60:63], v[172:175], v[160:163], v[60:63]
    s_waitcnt lgkmcnt(0)
    s_barrier
    v_add_u32 v14, 0, v12
    v_add_u32 v15, 0, v13
    ds_read_b128 v[120:123], v14 offset:0
    ds_read_b128 v[124:127], v14 offset:2048
    ds_read_b128 v[128:131], v14 offset:4096
    ds_read_b128 v[132:135], v14 offset:6144
    ds_read_b64_tr_b16 v[136:137], v15 offset:0
    ds_read_b64_tr_b16 v[138:139], v15 offset:768
    ds_read_b64_tr_b16 v[140:141], v15 offset:32
    ds_read_b64_tr_b16 v[142:143], v15 offset:800
    ds_read_b64_tr_b16 v[144:145], v15 offset:64
    ds_read_b64_tr_b16 v[146:147], v15 offset:832
    v_xor_b32 v14, 64, v14
    ds_read_b128 v[148:151], v14 offset:0
    ds_read_b128 v[152:155], v14 offset:2048
    ds_read_b128 v[156:159], v14 offset:4096
    ds_read_b128 v[160:163], v14 offset:6144
    ds_read_b64_tr_b16 v[164:165], v15 offset:6144
    ds_read_b64_tr_b16 v[166:167], v15 offset:6912
    ds_read_b64_tr_b16 v[168:169], v15 offset:6176
    ds_read_b64_tr_b16 v[170:171], v15 offset:6944
    ds_read_b64_tr_b16 v[172:173], v15 offset:6208
    ds_read_b64_tr_b16 v[174:175], v15 offset:6976
    v_mfma_f32_16x16x32_bf16 v[16:19], v[80:83], v[64:67], v[16:19]
    v_mfma_f32_16x16x32_bf16 v[20:23], v[80:83], v[68:71], v[20:23]
    v_mfma_f32_16x16x32_bf16 v[24:27], v[80:83], v[72:75], v[24:27]
    v_mfma_f32_16x16x32_bf16 v[28:31], v[80:83], v[76:79], v[28:31]
    v_mfma_f32_16x16x32_bf16 v[32:35], v[84:87], v[64:67], v[32:35]
    v_mfma_f32_16x16x32_bf16 v[36:39], v[84:87], v[68:71], v[36:39]
    v_mfma_f32_16x16x32_bf16 v[40:43], v[84:87], v[72:75], v[40:43]
    v_mfma_f32_16x16x32_bf16 v[44:47], v[84:87], v[76:79], v[44:47]
    v_mfma_f32_16x16x32_bf16 v[48:51], v[88:91], v[64:67], v[48:51]
    v_mfma_f32_16x16x32_bf16 v[52:55], v[88:91], v[68:71], v[52:55]
    v_mfma_f32_16x16x32_bf16 v[56:59], v[88:91], v[72:75], v[56:59]
    v_mfma_f32_16x16x32_bf16 v[60:63], v[88:91], v[76:79], v[60:63]
    v_mfma_f32_16x16x32_bf16 v[16:19], v[108:111], v[92:95], v[16:19]
    v_mfma_f32_16x16x32_bf16 v[20:23], v[108:111], v[96:99], v[20:23]
    v_mfma_f32_16x16x32_bf16 v[24:27], v[108:111], v[100:103], v[24:27]
    v_mfma_f32_16x16x32_bf16 v[28:31], v[108:111], v[104:107], v[28:31]
    v_mfma_f32_16x16x32_bf16 v[32:35], v[112:115], v[92:95], v[32:35]
    v_mfma_f32_16x16x32_bf16 v[36:39], v[112:115], v[96:99], v[36:39]
    v_mfma_f32_16x16x32_bf16 v[40:43], v[112:115], v[100:103], v[40:43]
    v_mfma_f32_16x16x32_bf16 v[44:47], v[112:115], v[104:107], v[44:47]
    v_mfma_f32_16x16x32_bf16 v[48:51], v[116:119], v[92:95], v[48:51]
    v_mfma_f32_16x16x32_bf16 v[52:55], v[116:119], v[96:99], v[52:55]
    v_mfma_f32_16x16x32_bf16 v[56:59], v[116:119], v[100:103], v[56:59]
    v_mfma_f32_16x16x32_bf16 v[60:63], v[116:119], v[104:107], v[60:63]
    s_waitcnt lgkmcnt(0)
    s_barrier
    v_add_u32 v14, 28672, v12
    v_add_u32 v15, 28672, v13
    ds_read_b128 v[64:67], v14 offset:0
    ds_read_b128 v[68:71], v14 offset:2048
    ds_read_b128 v[72:75], v14 offset:4096
    ds_read_b128 v[76:79], v14 offset:6144
    ds_read_b64_tr_b16 v[80:81], v15 offset:0
    ds_read_b64_tr_b16 v[82:83], v15 offset:768
    ds_read_b64_tr_b16 v[84:85], v15 offset:32
    ds_read_b64_tr_b16 v[86:87], v15 offset:800
    ds_read_b64_tr_b16 v[88:89], v15 offset:64
    ds_read_b64_tr_b16 v[90:91], v15 offset:832
    v_xor_b32 v14, 64, v14
    ds_read_b128 v[92:95], v14 offset:0
    ds_read_b128 v[96:99], v14 offset:2048
    ds_read_b128 v[100:103], v14 offset:4096
    ds_read_b128 v[104:107], v14 offset:6144
    ds_read_b64_tr_b16 v[108:109], v15 offset:6144
    ds_read_b64_tr_b16 v[110:111], v15 offset:6912
    ds_read_b64_tr_b16 v[112:113], v15 offset:6176
    ds_read_b64_tr_b16 v[114:115], v15 offset:6944
    ds_read_b64_tr_b16 v[116:117], v15 offset:6208
    ds_read_b64_tr_b16 v[118:119], v15 offset:6976
    v_mfma_f32_16x16x32_bf16 v[16:19], v[136:139], v[120:123], v[16:19]
    v_mfma_f32_16x16x32_bf16 v[20:23], v[136:139], v[124:127], v[20:23]
    v_mfma_f32_16x16x32_bf16 v[24:27], v[136:139], v[128:131], v[24:27]
    v_mfma_f32_16x16x32_bf16 v[28:31], v[136:139], v[132:135], v[28:31]
    v_mfma_f32_16x16x32_bf16 v[32:35], v[140:143], v[120:123], v[32:35]
    v_mfma_f32_16x16x32_bf16 v[36:39], v[140:143], v[124:127], v[36:39]
    v_mfma_f32_16x16x32_bf16 v[40:43], v[140:143], v[128:131], v[40:43]
    v_mfma_f32_16x16x32_bf16 v[44:47], v[140:143], v[132:135], v[44:47]
    v_mfma_f32_16x16x32_bf16 v[48:51], v[144:147], v[120:123], v[48:51]
    v_mfma_f32_16x16x32_bf16 v[52:55], v[144:147], v[124:127], v[52:55]
    v_mfma_f32_16x16x32_bf16 v[56:59], v[144:147], v[128:131], v[56:59]
    v_mfma_f32_16x16x32_bf16 v[60:63], v[144:147], v[132:135], v[60:63]
    v_mfma_f32_16x16x32_bf16 v[16:19], v[164:167], v[148:151], v[16:19]
    v_mfma_f32_16x16x32_bf16 v[20:23], v[164:167], v[152:155], v[20:23]
    v_mfma_f32_16x16x32_bf16 v[24:27], v[164:167], v[156:159], v[24:27]
    v_mfma_f32_16x16x32_bf16 v[28:31], v[164:167], v[160:163], v[28:31]
    v_mfma_f32_16x16x32_bf16 v[32:35], v[168:171], v[148:151], v[32:35]
    v_mfma_f32_16x16x32_bf16 v[36:39], v[168:171], v[152:155], v[36:39]
    v_mfma_f32_16x16x32_bf16 v[40:43], v[168:171], v[156:159], v[40:43]
    v_mfma_f32_16x16x32_bf16 v[44:47], v[168:171], v[160:163], v[44:47]
    v_mfma_f32_16x16x32_bf16 v[48:51], v[172:175], v[148:151], v[48:51]
    v_mfma_f32_16x16x32_bf16 v[52:55], v[172:175], v[152:155], v[52:55]
    v_mfma_f32_16x16x32_bf16 v[56:59], v[172:175], v[156:159], v[56:59]
    v_mfma_f32_16x16x32_bf16 v[60:63], v[172:175], v[160:163], v[60:63]
    s_waitcnt lgkmcnt(0)
    s_barrier
    v_add_u32 v14, 57344, v12
    v_add_u32 v15, 57344, v13
    ds_read_b128 v[120:123], v14 offset:0
    ds_read_b128 v[124:127], v14 offset:2048
    ds_read_b128 v[128:131], v14 offset:4096
    ds_read_b128 v[132:135], v14 offset:6144
    ds_read_b64_tr_b16 v[136:137], v15 offset:0
    ds_read_b64_tr_b16 v[138:139], v15 offset:768
    ds_read_b64_tr_b16 v[140:141], v15 offset:32
    ds_read_b64_tr_b16 v[142:143], v15 offset:800
    ds_read_b64_tr_b16 v[144:145], v15 offset:64
    ds_read_b64_tr_b16 v[146:147], v15 offset:832
    v_xor_b32 v14, 64, v14
    ds_read_b128 v[148:151], v14 offset:0
    ds_read_b128 v[152:155], v14 offset:2048
    ds_read_b128 v[156:159], v14 offset:4096
    ds_read_b128 v[160:163], v14 offset:6144
    ds_read_b64_tr_b16 v[164:165], v15 offset:6144
    ds_read_b64_tr_b16 v[166:167], v15 offset:6912
    ds_read_b64_tr_b16 v[168:169], v15 offset:6176
    ds_read_b64_tr_b16 v[170:171], v15 offset:6944
    ds_read_b64_tr_b16 v[172:173], v15 offset:6208
    ds_read_b64_tr_b16 v[174:175], v15 offset:6976
    v_mfma_f32_16x16x32_bf16 v[16:19], v[80:83], v[64:67], v[16:19]
    v_mfma_f32_16x16x32_bf16 v[20:23], v[80:83], v[68:71], v[20:23]
    v_mfma_f32_16x16x32_bf16 v[24:27], v[80:83], v[72:75], v[24:27]
    v_mfma_f32_16x16x32_bf16 v[28:31], v[80:83], v[76:79], v[28:31]
    v_mfma_f32_16x16x32_bf16 v[32:35], v[84:87], v[64:67], v[32:35]
    v_mfma_f32_16x16x32_bf16 v[36:39], v[84:87], v[68:71], v[36:39]
    v_mfma_f32_16x16x32_bf16 v[40:43], v[84:87], v[72:75], v[40:43]
    v_mfma_f32_16x16x32_bf16 v[44:47], v[84:87], v[76:79], v[44:47]
    v_mfma_f32_16x16x32_bf16 v[48:51], v[88:91], v[64:67], v[48:51]
    v_mfma_f32_16x16x32_bf16 v[52:55], v[88:91], v[68:71], v[52:55]
    v_mfma_f32_16x16x32_bf16 v[56:59], v[88:91], v[72:75], v[56:59]
    v_mfma_f32_16x16x32_bf16 v[60:63], v[88:91], v[76:79], v[60:63]
    v_mfma_f32_16x16x32_bf16 v[16:19], v[108:111], v[92:95], v[16:19]
    v_mfma_f32_16x16x32_bf16 v[20:23], v[108:111], v[96:99], v[20:23]
    v_mfma_f32_16x16x32_bf16 v[24:27], v[108:111], v[100:103], v[24:27]
    v_mfma_f32_16x16x32_bf16 v[28:31], v[108:111], v[104:107], v[28:31]
    v_mfma_f32_16x16x32_bf16 v[32:35], v[112:115], v[92:95], v[32:35]
    v_mfma_f32_16x16x32_bf16 v[36:39], v[112:115], v[96:99], v[36:39]
    v_mfma_f32_16x16x32_bf16 v[40:43], v[112:115], v[100:103], v[40:43]
    v_mfma_f32_16x16x32_bf16 v[44:47], v[112:115], v[104:107], v[44:47]
    v_mfma_f32_16x16x32_bf16 v[48:51], v[116:119], v[92:95], v[48:51]
    v_mfma_f32_16x16x32_bf16 v[52:55], v[116:119], v[96:99], v[52:55]
    v_mfma_f32_16x16x32_bf16 v[56:59], v[116:119], v[100:103], v[56:59]
    v_mfma_f32_16x16x32_bf16 v[60:63], v[116:119], v[104:107], v[60:63]
    s_waitcnt lgkmcnt(0)
    s_barrier
    v_add_u32 v14, 86016, v12
    v_add_u32 v15, 86016, v13
    ds_read_b128 v[64:67], v14 offset:0
    ds_read_b128 v[68:71], v14 offset:2048
    ds_read_b128 v[72:75], v14 offset:4096
    ds_read_b128 v[76:79], v14 offset:6144
    ds_read_b64_tr_b16 v[80:81], v15 offset:0
    ds_read_b64_tr_b16 v[82:83], v15 offset:768
    ds_read_b64_tr_b16 v[84:85], v15 offset:32
    ds_read_b64_tr_b16 v[86:87], v15 offset:800
    ds_read_b64_tr_b16 v[88:89], v15 offset:64
    ds_read_b64_tr_b16 v[90:91], v15 offset:832
    v_xor_b32 v14, 64, v14
    ds_read_b128 v[92:95], v14 offset:0
    ds_read_b128 v[96:99], v14 offset:2048
    ds_read_b128 v[100:103], v14 offset:4096
    ds_read_b128 v[104:107], v14 offset:6144
    ds_read_b64_tr_b16 v[108:109], v15 offset:6144
    ds_read_b64_tr_b16 v[110:111], v15 offset:6912
    ds_read_b64_tr_b16 v[112:113], v15 offset:6176
    ds_read_b64_tr_b16 v[114:115], v15 offset:6944
    ds_read_b64_tr_b16 v[116:117], v15 offset:6208
    ds_read_b64_tr_b16 v[118:119], v15 offset:6976
    v_mfma_f32_16x16x32_bf16 v[16:19], v[136:139], v[120:123], v[16:19]
    v_mfma_f32_16x16x32_bf16 v[20:23], v[136:139], v[124:127], v[20:23]
    v_mfma_f32_16x16x32_bf16 v[24:27], v[136:139], v[128:131], v[24:27]
    v_mfma_f32_16x16x32_bf16 v[28:31], v[136:139], v[132:135], v[28:31]
    v_mfma_f32_16x16x32_bf16 v[32:35], v[140:143], v[120:123], v[32:35]
    v_mfma_f32_16x16x32_bf16 v[36:39], v[140:143], v[124:127], v[36:39]
    v_mfma_f32_16x16x32_bf16 v[40:43], v[140:143], v[128:131], v[40:43]
    v_mfma_f32_16x16x32_bf16 v[44:47], v[140:143], v[132:135], v[44:47]
    v_mfma_f32_16x16x32_bf16 v[48:51], v[144:147], v[120:123], v[48:51]
    v_mfma_f32_16x16x32_bf16 v[52:55], v[144:147], v[124:127], v[52:55]
    v_mfma_f32_16x16x32_bf16 v[56:59], v[144:147], v[128:131], v[56:59]
    v_mfma_f32_16x16x32_bf16 v[60:63], v[144:147], v[132:135], v[60:63]
    v_mfma_f32_16x16x32_bf16 v[16:19], v[164:167], v[148:151], v[16:19]
    v_mfma_f32_16x16x32_bf16 v[20:23], v[164:167], v[152:155], v[20:23]
    v_mfma_f32_16x16x32_bf16 v[24:27], v[164:167], v[156:159], v[24:27]
    v_mfma_f32_16x16x32_bf16 v[28:31], v[164:167], v[160:163], v[28:31]
    v_mfma_f32_16x16x32_bf16 v[32:35], v[168:171], v[148:151], v[32:35]
    v_mfma_f32_16x16x32_bf16 v[36:39], v[168:171], v[152:155], v[36:39]
    v_mfma_f32_16x16x32_bf16 v[40:43], v[168:171], v[156:159], v[40:43]
    v_mfma_f32_16x16x32_bf16 v[44:47], v[168:171], v[160:163], v[44:47]
    v_mfma_f32_16x16x32_bf16 v[48:51], v[172:175], v[148:151], v[48:51]
    v_mfma_f32_16x16x32_bf16 v[52:55], v[172:175], v[152:155], v[52:55]
    v_mfma_f32_16x16x32_bf16 v[56:59], v[172:175], v[156:159], v[56:59]
    v_mfma_f32_16x16x32_bf16 v[60:63], v[172:175], v[160:163], v[60:63]
    s_waitcnt lgkmcnt(0)
    s_barrier
    v_add_u32 v14, 114688, v12
    v_add_u32 v15, 114688, v13
    ds_read_b128 v[120:123], v14 offset:0
    ds_read_b128 v[124:127], v14 offset:2048
    ds_read_b128 v[128:131], v14 offset:4096
    ds_read_b128 v[132:135], v14 offset:6144
    ds_read_b64_tr_b16 v[136:137], v15 offset:0
    ds_read_b64_tr_b16 v[138:139], v15 offset:768
    ds_read_b64_tr_b16 v[140:141], v15 offset:32
    ds_read_b64_tr_b16 v[142:143], v15 offset:800
    ds_read_b64_tr_b16 v[144:145], v15 offset:64
    ds_read_b64_tr_b16 v[146:147], v15 offset:832
    v_xor_b32 v14, 64, v14
    ds_read_b128 v[148:151], v14 offset:0
    ds_read_b128 v[152:155], v14 offset:2048
    ds_read_b128 v[156:159], v14 offset:4096
    ds_read_b128 v[160:163], v14 offset:6144
    ds_read_b64_tr_b16 v[164:165], v15 offset:6144
    ds_read_b64_tr_b16 v[166:167], v15 offset:6912
    ds_read_b64_tr_b16 v[168:169], v15 offset:6176
    ds_read_b64_tr_b16 v[170:171], v15 offset:6944
    ds_read_b64_tr_b16 v[172:173], v15 offset:6208
    ds_read_b64_tr_b16 v[174:175], v15 offset:6976
    v_mfma_f32_16x16x32_bf16 v[16:19], v[80:83], v[64:67], v[16:19]
    v_mfma_f32_16x16x32_bf16 v[20:23], v[80:83], v[68:71], v[20:23]
    v_mfma_f32_16x16x32_bf16 v[24:27], v[80:83], v[72:75], v[24:27]
    v_mfma_f32_16x16x32_bf16 v[28:31], v[80:83], v[76:79], v[28:31]
    v_mfma_f32_16x16x32_bf16 v[32:35], v[84:87], v[64:67], v[32:35]
    v_mfma_f32_16x16x32_bf16 v[36:39], v[84:87], v[68:71], v[36:39]
    v_mfma_f32_16x16x32_bf16 v[40:43], v[84:87], v[72:75], v[40:43]
    v_mfma_f32_16x16x32_bf16 v[44:47], v[84:87], v[76:79], v[44:47]
    v_mfma_f32_16x16x32_bf16 v[48:51], v[88:91], v[64:67], v[48:51]
    v_mfma_f32_16x16x32_bf16 v[52:55], v[88:91], v[68:71], v[52:55]
    v_mfma_f32_16x16x32_bf16 v[56:59], v[88:91], v[72:75], v[56:59]
    v_mfma_f32_16x16x32_bf16 v[60:63], v[88:91], v[76:79], v[60:63]
    v_mfma_f32_16x16x32_bf16 v[16:19], v[108:111], v[92:95], v[16:19]
    v_mfma_f32_16x16x32_bf16 v[20:23], v[108:111], v[96:99], v[20:23]
    v_mfma_f32_16x16x32_bf16 v[24:27], v[108:111], v[100:103], v[24:27]
    v_mfma_f32_16x16x32_bf16 v[28:31], v[108:111], v[104:107], v[28:31]
    v_mfma_f32_16x16x32_bf16 v[32:35], v[112:115], v[92:95], v[32:35]
    v_mfma_f32_16x16x32_bf16 v[36:39], v[112:115], v[96:99], v[36:39]
    v_mfma_f32_16x16x32_bf16 v[40:43], v[112:115], v[100:103], v[40:43]
    v_mfma_f32_16x16x32_bf16 v[44:47], v[112:115], v[104:107], v[44:47]
    v_mfma_f32_16x16x32_bf16 v[48:51], v[116:119], v[92:95], v[48:51]
    v_mfma_f32_16x16x32_bf16 v[52:55], v[116:119], v[96:99], v[52:55]
    v_mfma_f32_16x16x32_bf16 v[56:59], v[116:119], v[100:103], v[56:59]
    v_mfma_f32_16x16x32_bf16 v[60:63], v[116:119], v[104:107], v[60:63]
    s_waitcnt lgkmcnt(0)
    v_mfma_f32_16x16x32_bf16 v[16:19], v[136:139], v[120:123], v[16:19]
    v_mfma_f32_16x16x32_bf16 v[20:23], v[136:139], v[124:127], v[20:23]
    v_mfma_f32_16x16x32_bf16 v[24:27], v[136:139], v[128:131], v[24:27]
    v_mfma_f32_16x16x32_bf16 v[28:31], v[136:139], v[132:135], v[28:31]
    v_mfma_f32_16x16x32_bf16 v[32:35], v[140:143], v[120:123], v[32:35]
    v_mfma_f32_16x16x32_bf16 v[36:39], v[140:143], v[124:127], v[36:39]
    v_mfma_f32_16x16x32_bf16 v[40:43], v[140:143], v[128:131], v[40:43]
    v_mfma_f32_16x16x32_bf16 v[44:47], v[140:143], v[132:135], v[44:47]
    v_mfma_f32_16x16x32_bf16 v[48:51], v[144:147], v[120:123], v[48:51]
    v_mfma_f32_16x16x32_bf16 v[52:55], v[144:147], v[124:127], v[52:55]
    v_mfma_f32_16x16x32_bf16 v[56:59], v[144:147], v[128:131], v[56:59]
    v_mfma_f32_16x16x32_bf16 v[60:63], v[144:147], v[132:135], v[60:63]
    v_mfma_f32_16x16x32_bf16 v[16:19], v[164:167], v[148:151], v[16:19]
    v_mfma_f32_16x16x32_bf16 v[20:23], v[164:167], v[152:155], v[20:23]
    v_mfma_f32_16x16x32_bf16 v[24:27], v[164:167], v[156:159], v[24:27]
    v_mfma_f32_16x16x32_bf16 v[28:31], v[164:167], v[160:163], v[28:31]
    v_mfma_f32_16x16x32_bf16 v[32:35], v[168:171], v[148:151], v[32:35]
    v_mfma_f32_16x16x32_bf16 v[36:39], v[168:171], v[152:155], v[36:39]
    v_mfma_f32_16x16x32_bf16 v[40:43], v[168:171], v[156:159], v[40:43]
    v_mfma_f32_16x16x32_bf16 v[44:47], v[168:171], v[160:163], v[44:47]
    v_mfma_f32_16x16x32_bf16 v[48:51], v[172:175], v[148:151], v[48:51]
    v_mfma_f32_16x16x32_bf16 v[52:55], v[172:175], v[152:155], v[52:55]
    v_mfma_f32_16x16x32_bf16 v[56:59], v[172:175], v[156:159], v[56:59]
    v_mfma_f32_16x16x32_bf16 v[60:63], v[172:175], v[160:163], v[60:63]
    s_barrier
    ds_write_b128 v11, v[16:19] offset:0
    ds_write_b128 v11, v[32:35] offset:64
    s_nop 1
    ds_write_b128 v11, v[48:51] offset:128
    ds_write_b128 v11, v[20:23] offset:6400
    ds_write_b128 v11, v[36:39] offset:6464
    ds_write_b128 v11, v[52:55] offset:6528
    ds_write_b128 v11, v[24:27] offset:12800
    ds_write_b128 v11, v[40:43] offset:12864
    ds_write_b128 v11, v[56:59] offset:12928
    ds_write_b128 v11, v[28:31] offset:19200
    ds_write_b128 v11, v[44:47] offset:19264
    ds_write_b128 v11, v[60:63] offset:19328
.Lk4_epi:
    s_waitcnt lgkmcnt(0)
    s_barrier
    ds_read_b128 v[100:103], v200
    ds_read_b128 v[104:107], v200 offset:16
    ds_read_b128 v[124:127], v201
    ds_read_b128 v[128:131], v201 offset:16
    ds_read_b128 v[148:151], v202
    ds_read_b128 v[152:155], v202 offset:16
    s_waitcnt vmcnt(0) lgkmcnt(0)
    v_cvt_pk_bf16_f32 v116, v100, v101
    v_lshlrev_b32 v100, 16, v116
    v_and_b32 v101, 0xffff0000, v116
    v_lshlrev_b32 v116, 16, v208
    v_and_b32 v117, 0xffff0000, v208
    v_add_f32 v100, v100, v116
    v_add_f32 v101, v101, v117
    v_cvt_pk_bf16_f32 v116, v100, v101
    v_lshlrev_b32 v100, 16, v116
    v_and_b32 v101, 0xffff0000, v116
    v_max_f32 v100, 0, v100
    v_max_f32 v101, 0, v101
    v_mul_f32 v100, v100, v100
    v_mul_f32 v101, v101, v101
    v_cvt_pk_bf16_f32 v120, v100, v101
    v_cvt_pk_bf16_f32 v116, v102, v103
    v_lshlrev_b32 v102, 16, v116
    v_and_b32 v103, 0xffff0000, v116
    v_lshlrev_b32 v116, 16, v209
    v_and_b32 v117, 0xffff0000, v209
    v_add_f32 v102, v102, v116
    v_add_f32 v103, v103, v117
    v_cvt_pk_bf16_f32 v116, v102, v103
    v_lshlrev_b32 v102, 16, v116
    v_and_b32 v103, 0xffff0000, v116
    v_max_f32 v102, 0, v102
    v_max_f32 v103, 0, v103
    v_mul_f32 v102, v102, v102
    v_mul_f32 v103, v103, v103
    v_cvt_pk_bf16_f32 v121, v102, v103
    v_cvt_pk_bf16_f32 v116, v104, v105
    v_lshlrev_b32 v104, 16, v116
    v_and_b32 v105, 0xffff0000, v116
    v_lshlrev_b32 v116, 16, v210
    v_and_b32 v117, 0xffff0000, v210
    v_add_f32 v104, v104, v116
    v_add_f32 v105, v105, v117
    v_cvt_pk_bf16_f32 v116, v104, v105
    v_lshlrev_b32 v104, 16, v116
    v_and_b32 v105, 0xffff0000, v116
    v_max_f32 v104, 0, v104
    v_max_f32 v105, 0, v105
    v_mul_f32 v104, v104, v104
    v_mul_f32 v105, v105, v105
    v_cvt_pk_bf16_f32 v122, v104, v105
    v_cvt_pk_bf16_f32 v116, v106, v107
    v_lshlrev_b32 v106, 16, v116
    v_and_b32 v107, 0xffff0000, v116
    v_lshlrev_b32 v116, 16, v211
    v_and_b32 v117, 0xffff0000, v211
    v_add_f32 v106, v106, v116
    v_add_f32 v107, v107, v117
    v_cvt_pk_bf16_f32 v116, v106, v107
    v_lshlrev_b32 v106, 16, v116
    v_and_b32 v107, 0xffff0000, v116
    v_max_f32 v106, 0, v106
    v_max_f32 v107, 0, v107
    v_mul_f32 v106, v106, v106
    v_mul_f32 v107, v107, v107
    v_cvt_pk_bf16_f32 v123, v106, v107
    s_mov_b32 s8, 19922944
    buffer_store_dwordx4 v[120:123], v204, s[40:43], s8 offen
    v_cvt_pk_bf16_f32 v140, v124, v125
    v_lshlrev_b32 v124, 16, v140
    v_and_b32 v125, 0xffff0000, v140
    v_lshlrev_b32 v140, 16, v212
    v_and_b32 v141, 0xffff0000, v212
    v_add_f32 v124, v124, v140
    v_add_f32 v125, v125, v141
    v_cvt_pk_bf16_f32 v140, v124, v125
    v_lshlrev_b32 v124, 16, v140
    v_and_b32 v125, 0xffff0000, v140
    v_max_f32 v124, 0, v124
    v_max_f32 v125, 0, v125
    v_mul_f32 v124, v124, v124
    v_mul_f32 v125, v125, v125
    v_cvt_pk_bf16_f32 v144, v124, v125
    v_cvt_pk_bf16_f32 v140, v126, v127
    v_lshlrev_b32 v126, 16, v140
    v_and_b32 v127, 0xffff0000, v140
    v_lshlrev_b32 v140, 16, v213
    v_and_b32 v141, 0xffff0000, v213
    v_add_f32 v126, v126, v140
    v_add_f32 v127, v127, v141
    v_cvt_pk_bf16_f32 v140, v126, v127
    v_lshlrev_b32 v126, 16, v140
    v_and_b32 v127, 0xffff0000, v140
    v_max_f32 v126, 0, v126
    v_max_f32 v127, 0, v127
    v_mul_f32 v126, v126, v126
    v_mul_f32 v127, v127, v127
    v_cvt_pk_bf16_f32 v145, v126, v127
    v_cvt_pk_bf16_f32 v140, v128, v129
    v_lshlrev_b32 v128, 16, v140
    v_and_b32 v129, 0xffff0000, v140
    v_lshlrev_b32 v140, 16, v214
    v_and_b32 v141, 0xffff0000, v214
    v_add_f32 v128, v128, v140
    v_add_f32 v129, v129, v141
    v_cvt_pk_bf16_f32 v140, v128, v129
    v_lshlrev_b32 v128, 16, v140
    v_and_b32 v129, 0xffff0000, v140
    v_max_f32 v128, 0, v128
    v_max_f32 v129, 0, v129
    v_mul_f32 v128, v128, v128
    v_mul_f32 v129, v129, v129
    v_cvt_pk_bf16_f32 v146, v128, v129
    v_cvt_pk_bf16_f32 v140, v130, v131
    v_lshlrev_b32 v130, 16, v140
    v_and_b32 v131, 0xffff0000, v140
    v_lshlrev_b32 v140, 16, v215
    v_and_b32 v141, 0xffff0000, v215
    v_add_f32 v130, v130, v140
    v_add_f32 v131, v131, v141
    v_cvt_pk_bf16_f32 v140, v130, v131
    v_lshlrev_b32 v130, 16, v140
    v_and_b32 v131, 0xffff0000, v140
    v_max_f32 v130, 0, v130
    v_max_f32 v131, 0, v131
    v_mul_f32 v130, v130, v130
    v_mul_f32 v131, v131, v131
    v_cvt_pk_bf16_f32 v147, v130, v131
    s_mov_b32 s8, 19922944
    buffer_store_dwordx4 v[144:147], v205, s[40:43], s8 offen
    v_cvt_pk_bf16_f32 v164, v148, v149
    v_lshlrev_b32 v148, 16, v164
    v_and_b32 v149, 0xffff0000, v164
    v_lshlrev_b32 v164, 16, v216
    v_and_b32 v165, 0xffff0000, v216
    v_add_f32 v148, v148, v164
    v_add_f32 v149, v149, v165
    v_cvt_pk_bf16_f32 v164, v148, v149
    v_lshlrev_b32 v148, 16, v164
    v_and_b32 v149, 0xffff0000, v164
    v_max_f32 v148, 0, v148
    v_max_f32 v149, 0, v149
    v_mul_f32 v148, v148, v148
    v_mul_f32 v149, v149, v149
    v_cvt_pk_bf16_f32 v168, v148, v149
    v_cvt_pk_bf16_f32 v164, v150, v151
    v_lshlrev_b32 v150, 16, v164
    v_and_b32 v151, 0xffff0000, v164
    v_lshlrev_b32 v164, 16, v217
    v_and_b32 v165, 0xffff0000, v217
    v_add_f32 v150, v150, v164
    v_add_f32 v151, v151, v165
    v_cvt_pk_bf16_f32 v164, v150, v151
    v_lshlrev_b32 v150, 16, v164
    v_and_b32 v151, 0xffff0000, v164
    v_max_f32 v150, 0, v150
    v_max_f32 v151, 0, v151
    v_mul_f32 v150, v150, v150
    v_mul_f32 v151, v151, v151
    v_cvt_pk_bf16_f32 v169, v150, v151
    v_cvt_pk_bf16_f32 v164, v152, v153
    v_lshlrev_b32 v152, 16, v164
    v_and_b32 v153, 0xffff0000, v164
    v_lshlrev_b32 v164, 16, v218
    v_and_b32 v165, 0xffff0000, v218
    v_add_f32 v152, v152, v164
    v_add_f32 v153, v153, v165
    v_cvt_pk_bf16_f32 v164, v152, v153
    v_lshlrev_b32 v152, 16, v164
    v_and_b32 v153, 0xffff0000, v164
    v_max_f32 v152, 0, v152
    v_max_f32 v153, 0, v153
    v_mul_f32 v152, v152, v152
    v_mul_f32 v153, v153, v153
    v_cvt_pk_bf16_f32 v170, v152, v153
    v_cvt_pk_bf16_f32 v164, v154, v155
    v_lshlrev_b32 v154, 16, v164
    v_and_b32 v155, 0xffff0000, v164
    v_lshlrev_b32 v164, 16, v219
    v_and_b32 v165, 0xffff0000, v219
    v_add_f32 v154, v154, v164
    v_add_f32 v155, v155, v165
    v_cvt_pk_bf16_f32 v164, v154, v155
    v_lshlrev_b32 v154, 16, v164
    v_and_b32 v155, 0xffff0000, v164
    v_max_f32 v154, 0, v154
    v_max_f32 v155, 0, v155
    v_mul_f32 v154, v154, v154
    v_mul_f32 v155, v155, v155
    v_cvt_pk_bf16_f32 v171, v154, v155
    s_mov_b32 s8, 19922944
    buffer_store_dwordx4 v[168:171], v206, s[40:43], s8 offen
    s_waitcnt vmcnt(0)
.Lk4_end:
    s_endpgm

.globl k5_gemm2_kernel
.p2align 8
.type k5_gemm2_kernel,@function
k5_gemm2_kernel:
    s_cmp_ge_u32 s2, 256
    s_cbranch_scc1 .Lk5_end
    s_load_dwordx4 s[16:19], s[0:1], 48
    s_load_dwordx2 s[20:21], s[0:1], 64
    s_load_dwordx2 s[24:25], s[0:1], 80
    v_lshrrev_b32 v1, 6, v0
    s_nop 0
    v_readfirstlane_b32 s3, v1
    s_and_b32 s4, s2, 7
    s_lshr_b32 s5, s2, 3
    s_lshl_b32 s6, s4, 2
    s_lshr_b32 s7, s5, 3
    s_add_u32 s6, s6, s7
    s_and_b32 s7, s5, 7
    s_mul_i32 s6, s6, 64
    s_mul_i32 s7, s7, 80
    v_and_b32 v3, 63, v0
    s_waitcnt lgkmcnt(0)
    s_mov_b32 s40, s24
    s_and_b32 s41, s25, 0xffff
    s_mov_b32 s42, 0x2000000
    s_mov_b32 s43, 0x00020000
    s_mov_b32 s36, s18
    s_and_b32 s37, s19, 0xffff
    s_mov_b32 s38, 0x500
    s_mov_b32 s39, 0x00020000
    s_mov_b32 s32, s20
    s_and_b32 s33, s21, 0xffff
    s_mov_b32 s34, 0x280000
    s_mov_b32 s35, 0x00020000
    v_add_u32 v4, 0, v0
    v_mul_u32_u24 v204, 52429, v4
    v_lshrrev_b32 v204, 19, v204
    v_mul_u32_u24 v200, 10, v204
    v_sub_u32 v4, v4, v200
    v_mul_u32_u24 v200, 336, v204
    v_lshl_add_u32 v200, v4, 5, v200
    v_add_u32 v204, s6, v204
    v_mul_u32_u24 v204, 1280, v204
    v_lshl_add_u32 v4, v4, 3, s7
    v_lshlrev_b32 v4, 1, v4
    v_add_u32 v204, v204, v4
    buffer_load_dwordx4 v[208:211], v4, s[36:39], 0 offen
    s_mov_b32 s8, 8388608
    buffer_load_dwordx4 v[224:227], v204, s[40:43], s8 offen
    v_add_u32 v4, 512, v0
    v_mul_u32_u24 v205, 52429, v4
    v_lshrrev_b32 v205, 19, v205
    v_mul_u32_u24 v201, 10, v205
    v_sub_u32 v4, v4, v201
    v_mul_u32_u24 v201, 336, v205
    v_lshl_add_u32 v201, v4, 5, v201
    v_add_u32 v205, s6, v205
    v_mul_u32_u24 v205, 1280, v205
    v_lshl_add_u32 v4, v4, 3, s7
    v_lshlrev_b32 v4, 1, v4
    v_add_u32 v205, v205, v4
    buffer_load_dwordx4 v[212:215], v4, s[36:39], 0 offen
    s_mov_b32 s8, 8388608
    buffer_load_dwordx4 v[228:231], v205, s[40:43], s8 offen
    s_cmp_lt_u32 s3, 4
    s_cbranch_scc1 .Lk5_cons
    s_mov_b32 s44, s16
    s_and_b32 s45, s17, 0xffff
    s_mov_b32 s46, 0x1e0000
    s_mov_b32 s47, 0x00020000
    s_sub_u32 s3, s3, 4
    v_lshrrev_b32 v4, 3, v3
    v_and_b32 v5, 7, v3
    v_xor_b32 v5, v5, v4
    v_lshlrev_b32 v5, 4, v5
    v_mul_u32_u24 v4, 3328, v4
    v_add_u32 v5, v5, v4
    v_add_u32 v4, 0, v3
    v_mul_u32_u24 v11, 52429, v4
    v_lshrrev_b32 v11, 19, v11
    v_mul_u32_u24 v6, 10, v11
    v_sub_u32 v4, v4, v6
    v_mul_u32_u24 v11, 1280, v11
    v_lshl_add_u32 v6, v4, 4, v11
    v_add_u32 v4, 64, v3
    v_mul_u32_u24 v11, 52429, v4
    v_lshrrev_b32 v11, 19, v11
    v_mul_u32_u24 v7, 10, v11
    v_sub_u32 v4, v4, v7
    v_mul_u32_u24 v11, 1280, v11
    v_lshl_add_u32 v7, v4, 4, v11
    v_add_u32 v4, 128, v3
    v_mul_u32_u24 v11, 52429, v4
    v_lshrrev_b32 v11, 19, v11
    v_mul_u32_u24 v8, 10, v11
    v_sub_u32 v4, v4, v8
    v_mul_u32_u24 v11, 1280, v11
    v_lshl_add_u32 v8, v4, 4, v11
    v_add_u32 v4, 192, v3
    v_mul_u32_u24 v11, 52429, v4
    v_lshrrev_b32 v11, 19, v11
    v_mul_u32_u24 v9, 10, v11
    v_sub_u32 v4, v4, v9
    v_mul_u32_u24 v11, 1280, v11
    v_lshl_add_u32 v9, v4, 4, v11
    v_add_u32 v4, 256, v3
    v_mul_u32_u24 v11, 52429, v4
    v_lshrrev_b32 v11, 19, v11
    v_mul_u32_u24 v10, 10, v11
    v_sub_u32 v4, v4, v10
    v_mul_u32_u24 v11, 1280, v11
    v_lshl_add_u32 v10, v4, 4, v11
    s_add_u32 s8, s3, 0
    s_cmp_ge_u32 s8, 8
    s_cselect_b32 s10, 8, 0
    s_cselect_b32 s9, 128, 0
    s_cselect_b32 s11, 18432, 0
    s_sub_u32 s10, s8, s10
    s_lshl_b32 s12, s10, 10
    s_add_u32 s64, s12, s11
    s_lshl_b32 s10, s10, 3
    s_add_u32 s10, s10, s6
    s_mul_i32 s10, s10, 3328
    s_add_u32 s10, s10, 19922944
    s_add_u32 s48, s10, s9
    s_add_u32 s8, s3, 4
    s_cmp_ge_u32 s8, 8
    s_cselect_b32 s10, 8, 0
    s_cselect_b32 s9, 128, 0
    s_cselect_b32 s11, 18432, 0
    s_sub_u32 s10, s8, s10
    s_lshl_b32 s12, s10, 10
    s_add_u32 s65, s12, s11
    s_lshl_b32 s10, s10, 3
    s_add_u32 s10, s10, s6
    s_mul_i32 s10, s10, 3328
    s_add_u32 s10, s10, 19922944
    s_add_u32 s49, s10, s9
    s_add_u32 s8, s3, 8
    s_cmp_ge_u32 s8, 8
    s_cselect_b32 s10, 8, 0
    s_cselect_b32 s9, 128, 0
    s_cselect_b32 s11, 18432, 0
    s_sub_u32 s10, s8, s10
    s_lshl_b32 s12, s10, 10
    s_add_u32 s66, s12, s11
    s_lshl_b32 s10, s10, 3
    s_add_u32 s10, s10, s6
    s_mul_i32 s10, s10, 3328
    s_add_u32 s10, s10, 19922944
    s_add_u32 s50, s10, s9
    s_add_u32 s8, s3, 12
    s_cmp_ge_u32 s8, 8
    s_cselect_b32 s10, 8, 0
    s_cselect_b32 s9, 128, 0
    s_cselect_b32 s11, 18432, 0
    s_sub_u32 s10, s8, s10
    s_lshl_b32 s12, s10, 10
    s_add_u32 s67, s12, s11
    s_lshl_b32 s10, s10, 3
    s_add_u32 s10, s10, s6
    s_mul_i32 s10, s10, 3328
    s_add_u32 s10, s10, 19922944
    s_add_u32 s51, s10, s9
    s_mul_i32 s10, s3, 40960
    s_lshl_b32 s11, s7, 1
    s_add_u32 s56, s10, s11
    s_lshr_b32 s10, s3, 1
    s_mul_i32 s10, s10, 18432
    s_and_b32 s11, s3, 1
    s_mul_i32 s11, s11, 5120
    s_add_u32 s57, s10, s11
    s_add_u32 s57, s57, 8192
    s_add_u32 m0, s64, 0
    s_add_u32 s8, s48, 0
    buffer_load_dwordx4 v5, s[40:43], s8 offen lds
    s_add_u32 m0, s65, 0
    s_add_u32 s8, s49, 0
    buffer_load_dwordx4 v5, s[40:43], s8 offen lds
    s_add_u32 m0, s66, 0
    s_add_u32 s8, s50, 0
    buffer_load_dwordx4 v5, s[40:43], s8 offen lds
    s_add_u32 m0, s67, 0
    s_add_u32 s8, s51, 0
    buffer_load_dwordx4 v5, s[40:43], s8 offen lds
    s_add_u32 s8, s56, 0
    s_add_u32 m0, s57, 0
    s_nop 0
    buffer_load_dwordx4 v6, s[44:47], s8 offen lds
    s_add_u32 m0, s57, 1024
    s_nop 0
    buffer_load_dwordx4 v7, s[44:47], s8 offen lds
    s_add_u32 m0, s57, 2048
    s_nop 0
    buffer_load_dwordx4 v8, s[44:47], s8 offen lds
    s_add_u32 m0, s57, 3072
    s_nop 0
    buffer_load_dwordx4 v9, s[44:47], s8 offen lds
    s_add_u32 m0, s57, 4096
    s_nop 0
    buffer_load_dwordx4 v10, s[44:47], s8 offen lds
    s_add_u32 m0, s64, 36864
    s_add_u32 s8, s48, 256
    buffer_load_dwordx4 v5, s[40:43], s8 offen lds
    s_add_u32 m0, s65, 36864
    s_add_u32 s8, s49, 256
    buffer_load_dwordx4 v5, s[40:43], s8 offen lds
    s_add_u32 m0, s66, 36864
    s_add_u32 s8, s50, 256
    buffer_load_dwordx4 v5, s[40:43], s8 offen lds
    s_add_u32 m0, s67, 36864
    s_add_u32 s8, s51, 256
    buffer_load_dwordx4 v5, s[40:43], s8 offen lds
    s_add_u32 s8, s56, 163840
    s_add_u32 m0, s57, 36864
    s_nop 0
    buffer_load_dwordx4 v6, s[44:47], s8 offen lds
    s_add_u32 m0, s57, 37888
    s_nop 0
    buffer_load_dwordx4 v7, s[44:47], s8 offen lds
    s_add_u32 m0, s57, 38912
    s_nop 0
    buffer_load_dwordx4 v8, s[44:47], s8 offen lds
    s_add_u32 m0, s57, 39936
    s_nop 0
    buffer_load_dwordx4 v9, s[44:47], s8 offen lds
    s_add_u32 m0, s57, 40960
    s_nop 0
    buffer_load_dwordx4 v10, s[44:47], s8 offen lds
    s_waitcnt vmcnt(9)
    s_barrier
    s_add_u32 m0, s64, 73728
    s_add_u32 s8, s48, 512
    buffer_load_dwordx4 v5, s[40:43], s8 offen lds
    s_add_u32 m0, s65, 73728
    s_add_u32 s8, s49, 512
    buffer_load_dwordx4 v5, s[40:43], s8 offen lds
    s_add_u32 m0, s66, 73728
    s_add_u32 s8, s50, 512
    buffer_load_dwordx4 v5, s[40:43], s8 offen lds
    s_add_u32 m0, s67, 73728
    s_add_u32 s8, s51, 512
    buffer_load_dwordx4 v5, s[40:43], s8 offen lds
    s_add_u32 s8, s56, 327680
    s_add_u32 m0, s57, 73728
    s_nop 0
    buffer_load_dwordx4 v6, s[44:47], s8 offen lds
    s_add_u32 m0, s57, 74752
    s_nop 0
    buffer_load_dwordx4 v7, s[44:47], s8 offen lds
    s_add_u32 m0, s57, 75776
    s_nop 0
    buffer_load_dwordx4 v8, s[44:47], s8 offen lds
    s_add_u32 m0, s57, 76800
    s_nop 0
    buffer_load_dwordx4 v9, s[44:47], s8 offen lds
    s_add_u32 m0, s57, 77824
    s_nop 0
    buffer_load_dwordx4 v10, s[44:47], s8 offen lds
    s_add_u32 m0, s64, 110592
    s_add_u32 s8, s48, 768
    buffer_load_dwordx4 v5, s[40:43], s8 offen lds
    s_add_u32 m0, s65, 110592
    s_add_u32 s8, s49, 768
    buffer_load_dwordx4 v5, s[40:43], s8 offen lds
    s_add_u32 m0, s66, 110592
    s_add_u32 s8, s50, 768
    buffer_load_dwordx4 v5, s[40:43], s8 offen lds
    s_add_u32 m0, s67, 110592
    s_add_u32 s8, s51, 768
    buffer_load_dwordx4 v5, s[40:43], s8 offen lds
    s_add_u32 s8, s56, 491520
    s_add_u32 m0, s57, 110592
    s_nop 0
    buffer_load_dwordx4 v6, s[44:47], s8 offen lds
    s_add_u32 m0, s57, 111616
    s_nop 0
    buffer_load_dwordx4 v7, s[44:47], s8 offen lds
    s_add_u32 m0, s57, 112640
    s_nop 0
    buffer_load_dwordx4 v8, s[44:47], s8 offen lds
    s_add_u32 m0, s57, 113664
    s_nop 0
    buffer_load_dwordx4 v9, s[44:47], s8 offen lds
    s_add_u32 m0, s57, 114688
    s_nop 0
    buffer_load_dwordx4 v10, s[44:47], s8 offen lds
    s_waitcnt vmcnt(18)
    s_barrier
    s_add_u32 m0, s64, 0
    s_add_u32 s8, s48, 1024
    buffer_load_dwordx4 v5, s[40:43], s8 offen lds
    s_add_u32 m0, s65, 0
    s_add_u32 s8, s49, 1024
    buffer_load_dwordx4 v5, s[40:43], s8 offen lds
    s_add_u32 m0, s66, 0
    s_add_u32 s8, s50, 1024
    buffer_load_dwordx4 v5, s[40:43], s8 offen lds
    s_add_u32 m0, s67, 0
    s_add_u32 s8, s51, 1024
    buffer_load_dwordx4 v5, s[40:43], s8 offen lds
    s_add_u32 s8, s56, 655360
    s_add_u32 m0, s57, 0
    s_nop 0
    buffer_load_dwordx4 v6, s[44:47], s8 offen lds
    s_add_u32 m0, s57, 1024
    s_nop 0
    buffer_load_dwordx4 v7, s[44:47], s8 offen lds
    s_add_u32 m0, s57, 2048
    s_nop 0
    buffer_load_dwordx4 v8, s[44:47], s8 offen lds
    s_add_u32 m0, s57, 3072
    s_nop 0
    buffer_load_dwordx4 v9, s[44:47], s8 offen lds
    s_add_u32 m0, s57, 4096
    s_nop 0
    buffer_load_dwordx4 v10, s[44:47], s8 offen lds
    s_waitcnt vmcnt(18)
    s_barrier
    s_add_u32 m0, s64, 36864
    s_add_u32 s8, s48, 1280
    buffer_load_dwordx4 v5, s[40:43], s8 offen lds
    s_add_u32 m0, s65, 36864
    s_add_u32 s8, s49, 1280
    buffer_load_dwordx4 v5, s[40:43], s8 offen lds
    s_add_u32 m0, s66, 36864
    s_add_u32 s8, s50, 1280
    buffer_load_dwordx4 v5, s[40:43], s8 offen lds
    s_add_u32 m0, s67, 36864
    s_add_u32 s8, s51, 1280
    buffer_load_dwordx4 v5, s[40:43], s8 offen lds
    s_add_u32 s8, s56, 819200
    s_add_u32 m0, s57, 36864
    s_nop 0
    buffer_load_dwordx4 v6, s[44:47], s8 offen lds
    s_add_u32 m0, s57, 37888
    s_nop 0
    buffer_load_dwordx4 v7, s[44:47], s8 offen lds
    s_add_u32 m0, s57, 38912
    s_nop 0
    buffer_load_dwordx4 v8, s[44:47], s8 offen lds
    s_add_u32 m0, s57, 39936
    s_nop 0
    buffer_load_dwordx4 v9, s[44:47], s8 offen lds
    s_add_u32 m0, s57, 40960
    s_nop 0
    buffer_load_dwordx4 v10, s[44:47], s8 offen lds
    s_waitcnt vmcnt(18)
    s_barrier
    s_add_u32 m0, s64, 73728
    s_add_u32 s8, s48, 1536
    buffer_load_dwordx4 v5, s[40:43], s8 offen lds
    s_add_u32 m0, s65, 73728
    s_add_u32 s8, s49, 1536
    buffer_load_dwordx4 v5, s[40:43], s8 offen lds
    s_add_u32 m0, s66, 73728
    s_add_u32 s8, s50, 1536
    buffer_load_dwordx4 v5, s[40:43], s8 offen lds
    s_add_u32 m0, s67, 73728
    s_add_u32 s8, s51, 1536
    buffer_load_dwordx4 v5, s[40:43], s8 offen lds
    s_add_u32 s8, s56, 983040
    s_add_u32 m0, s57, 73728
    s_nop 0
    buffer_load_dwordx4 v6, s[44:47], s8 offen lds
    s_add_u32 m0, s57, 74752
    s_nop 0
    buffer_load_dwordx4 v7, s[44:47], s8 offen lds
    s_add_u32 m0, s57, 75776
    s_nop 0
    buffer_load_dwordx4 v8, s[44:47], s8 offen lds
    s_add_u32 m0, s57, 76800
    s_nop 0
    buffer_load_dwordx4 v9, s[44:47], s8 offen lds
    s_add_u32 m0, s57, 77824
    s_nop 0
    buffer_load_dwordx4 v10, s[44:47], s8 offen lds
    s_waitcnt vmcnt(18)
    s_barrier
    s_add_u32 m0, s64, 110592
    s_add_u32 s8, s48, 1792
    buffer_load_dwordx4 v5, s[40:43], s8 offen lds
    s_add_u32 m0, s65, 110592
    s_add_u32 s8, s49, 1792
    buffer_load_dwordx4 v5, s[40:43], s8 offen lds
    s_add_u32 m0, s66, 110592
    s_add_u32 s8, s50, 1792
    buffer_load_dwordx4 v5, s[40:43], s8 offen lds
    s_add_u32 m0, s67, 110592
    s_add_u32 s8, s51, 1792
    buffer_load_dwordx4 v5, s[40:43], s8 offen lds
    s_add_u32 s8, s56, 1146880
    s_add_u32 m0, s57, 110592
    s_nop 0
    buffer_load_dwordx4 v6, s[44:47], s8 offen lds
    s_add_u32 m0, s57, 111616
    s_nop 0
    buffer_load_dwordx4 v7, s[44:47], s8 offen lds
    s_add_u32 m0, s57, 112640
    s_nop 0
    buffer_load_dwordx4 v8, s[44:47], s8 offen lds
    s_add_u32 m0, s57, 113664
    s_nop 0
    buffer_load_dwordx4 v9, s[44:47], s8 offen lds
    s_add_u32 m0, s57, 114688
    s_nop 0
    buffer_load_dwordx4 v10, s[44:47], s8 offen lds
    s_waitcnt vmcnt(18)
    s_barrier
    s_add_u32 m0, s64, 0
    s_add_u32 s8, s48, 2048
    buffer_load_dwordx4 v5, s[40:43], s8 offen lds
    s_add_u32 m0, s65, 0
    s_add_u32 s8, s49, 2048
    buffer_load_dwordx4 v5, s[40:43], s8 offen lds
    s_add_u32 m0, s66, 0
    s_add_u32 s8, s50, 2048
    buffer_load_dwordx4 v5, s[40:43], s8 offen lds
    s_add_u32 m0, s67, 0
    s_add_u32 s8, s51, 2048
    buffer_load_dwordx4 v5, s[40:43], s8 offen lds
    s_add_u32 s8, s56, 1310720
    s_add_u32 m0, s57, 0
    s_nop 0
    buffer_load_dwordx4 v6, s[44:47], s8 offen lds
    s_add_u32 m0, s57, 1024
    s_nop 0
    buffer_load_dwordx4 v7, s[44:47], s8 offen lds
    s_add_u32 m0, s57, 2048
    s_nop 0
    buffer_load_dwordx4 v8, s[44:47], s8 offen lds
    s_add_u32 m0, s57, 3072
    s_nop 0
    buffer_load_dwordx4 v9, s[44:47], s8 offen lds
    s_add_u32 m0, s57, 4096
    s_nop 0
    buffer_load_dwordx4 v10, s[44:47], s8 offen lds
    s_waitcnt vmcnt(18)
    s_barrier
    s_add_u32 m0, s64, 36864
    s_add_u32 s8, s48, 2304
    buffer_load_dwordx4 v5, s[40:43], s8 offen lds
    s_add_u32 m0, s65, 36864
    s_add_u32 s8, s49, 2304
    buffer_load_dwordx4 v5, s[40:43], s8 offen lds
    s_add_u32 m0, s66, 36864
    s_add_u32 s8, s50, 2304
    buffer_load_dwordx4 v5, s[40:43], s8 offen lds
    s_add_u32 m0, s67, 36864
    s_add_u32 s8, s51, 2304
    buffer_load_dwordx4 v5, s[40:43], s8 offen lds
    s_add_u32 s8, s56, 1474560
    s_add_u32 m0, s57, 36864
    s_nop 0
    buffer_load_dwordx4 v6, s[44:47], s8 offen lds
    s_add_u32 m0, s57, 37888
    s_nop 0
    buffer_load_dwordx4 v7, s[44:47], s8 offen lds
    s_add_u32 m0, s57, 38912
    s_nop 0
    buffer_load_dwordx4 v8, s[44:47], s8 offen lds
    s_add_u32 m0, s57, 39936
    s_nop 0
    buffer_load_dwordx4 v9, s[44:47], s8 offen lds
    s_add_u32 m0, s57, 40960
    s_nop 0
    buffer_load_dwordx4 v10, s[44:47], s8 offen lds
    s_waitcnt vmcnt(18)
    s_barrier
    s_add_u32 m0, s64, 73728
    s_add_u32 s8, s48, 2560
    buffer_load_dwordx4 v5, s[40:43], s8 offen lds
    s_add_u32 m0, s65, 73728
    s_add_u32 s8, s49, 2560
    buffer_load_dwordx4 v5, s[40:43], s8 offen lds
    s_add_u32 m0, s66, 73728
    s_add_u32 s8, s50, 2560
    buffer_load_dwordx4 v5, s[40:43], s8 offen lds
    s_add_u32 m0, s67, 73728
    s_add_u32 s8, s51, 2560
    buffer_load_dwordx4 v5, s[40:43], s8 offen lds
    s_add_u32 s8, s56, 1638400
    s_add_u32 m0, s57, 73728
    s_nop 0
    buffer_load_dwordx4 v6, s[44:47], s8 offen lds
    s_add_u32 m0, s57, 74752
    s_nop 0
    buffer_load_dwordx4 v7, s[44:47], s8 offen lds
    s_add_u32 m0, s57, 75776
    s_nop 0
    buffer_load_dwordx4 v8, s[44:47], s8 offen lds
    s_add_u32 m0, s57, 76800
    s_nop 0
    buffer_load_dwordx4 v9, s[44:47], s8 offen lds
    s_add_u32 m0, s57, 77824
    s_nop 0
    buffer_load_dwordx4 v10, s[44:47], s8 offen lds
    s_waitcnt vmcnt(18)
    s_barrier
    s_add_u32 m0, s64, 110592
    s_add_u32 s8, s48, 2816
    buffer_load_dwordx4 v5, s[40:43], s8 offen lds
    s_add_u32 m0, s65, 110592
    s_add_u32 s8, s49, 2816
    buffer_load_dwordx4 v5, s[40:43], s8 offen lds
    s_add_u32 m0, s66, 110592
    s_add_u32 s8, s50, 2816
    buffer_load_dwordx4 v5, s[40:43], s8 offen lds
    s_add_u32 m0, s67, 110592
    s_add_u32 s8, s51, 2816
    buffer_load_dwordx4 v5, s[40:43], s8 offen lds
    s_add_u32 s8, s56, 1802240
    s_add_u32 m0, s57, 110592
    s_nop 0
    buffer_load_dwordx4 v6, s[44:47], s8 offen lds
    s_add_u32 m0, s57, 111616
    s_nop 0
    buffer_load_dwordx4 v7, s[44:47], s8 offen lds
    s_add_u32 m0, s57, 112640
    s_nop 0
    buffer_load_dwordx4 v8, s[44:47], s8 offen lds
    s_add_u32 m0, s57, 113664
    s_nop 0
    buffer_load_dwordx4 v9, s[44:47], s8 offen lds
    s_add_u32 m0, s57, 114688
    s_nop 0
    buffer_load_dwordx4 v10, s[44:47], s8 offen lds
    s_waitcnt vmcnt(18)
    s_barrier
    s_waitcnt vmcnt(9)
    s_barrier
    s_waitcnt vmcnt(0)
    s_barrier
    s_barrier
    s_branch .Lk5_epi
.Lk5_cons:
    v_lshrrev_b32 v12, 4, v3
    s_and_b32 s8, s3, 1
    s_lshl_b32 s8, s8, 5
    s_mul_i32 s8, s8, 336
    s_lshr_b32 s9, s3, 1
    s_mul_i32 s9, s9, 21504
    s_add_u32 s8, s8, s9
    v_and_b32 v13, 15, v3
    v_mul_u32_u24 v13, 336, v13
    v_lshl_add_u32 v13, v12, 4, v13
    v_add_u32 v13, s8, v13
    v_and_b32 v4, 7, v3
    v_xor_b32 v4, v4, v12
    v_lshlrev_b32 v4, 4, v4
    v_and_b32 v14, 15, v3
    v_lshl_add_u32 v14, v14, 7, v4
    v_and_b32 v4, 15, v3
    v_lshrrev_b32 v15, 2, v4
    v_lshl_add_u32 v15, v12, 3, v15
    v_mul_u32_u24 v15, 160, v15
    v_and_b32 v4, 3, v4
    v_lshl_add_u32 v15, v4, 3, v15
    s_lshr_b32 s10, s3, 1
    s_mul_i32 s10, s10, 18432
    s_and_b32 s8, s3, 1
    s_mul_i32 s8, s8, 4096
    s_add_u32 s8, s8, s10
    s_add_u32 s9, s10, 8192
    v_add_u32 v15, s9, v15
    v_add_u32 v14, s8, v14
    v_mov_b32 v16, 0
    v_mov_b32 v17, 0
    v_mov_b32 v18, 0
    v_mov_b32 v19, 0
    v_mov_b32 v20, 0
    v_mov_b32 v21, 0
    v_mov_b32 v22, 0
    v_mov_b32 v23, 0
    v_mov_b32 v24, 0
    v_mov_b32 v25, 0
    v_mov_b32 v26, 0
    v_mov_b32 v27, 0
    v_mov_b32 v28, 0
    v_mov_b32 v29, 0
    v_mov_b32 v30, 0
    v_mov_b32 v31, 0
    v_mov_b32 v32, 0
    v_mov_b32 v33, 0
    v_mov_b32 v34, 0
    v_mov_b32 v35, 0
    v_mov_b32 v36, 0
    v_mov_b32 v37, 0
    v_mov_b32 v38, 0
    v_mov_b32 v39, 0
    v_mov_b32 v40, 0
    v_mov_b32 v41, 0
    v_mov_b32 v42, 0
    v_mov_b32 v43, 0
    v_mov_b32 v44, 0
    v_mov_b32 v45, 0
    v_mov_b32 v46, 0
    v_mov_b32 v47, 0
    v_mov_b32 v48, 0
    v_mov_b32 v49, 0
    v_mov_b32 v50, 0
    v_mov_b32 v51, 0
    v_mov_b32 v52, 0
    v_mov_b32 v53, 0
    v_mov_b32 v54, 0
    v_mov_b32 v55, 0
    s_barrier
    v_add_u32 v168, 0, v14
    v_add_u32 v169, 0, v15
    ds_read_b128 v[56:59], v168 offset:0
    ds_read_b128 v[60:63], v168 offset:2048
    ds_read_b64_tr_b16 v[64:65], v169 offset:0
    ds_read_b64_tr_b16 v[66:67], v169 offset:640
    ds_read_b64_tr_b16 v[68:69], v169 offset:32
    ds_read_b64_tr_b16 v[70:71], v169 offset:672
    ds_read_b64_tr_b16 v[72:73], v169 offset:64
    ds_read_b64_tr_b16 v[74:75], v169 offset:704
    ds_read_b64_tr_b16 v[76:77], v169 offset:96
    ds_read_b64_tr_b16 v[78:79], v169 offset:736
    ds_read_b64_tr_b16 v[80:81], v169 offset:128
    ds_read_b64_tr_b16 v[82:83], v169 offset:768
    v_xor_b32 v168, 64, v168
    ds_read_b128 v[84:87], v168 offset:0
    ds_read_b128 v[88:91], v168 offset:2048
    ds_read_b64_tr_b16 v[92:93], v169 offset:5120
    ds_read_b64_tr_b16 v[94:95], v169 offset:5760
    ds_read_b64_tr_b16 v[96:97], v169 offset:5152
    ds_read_b64_tr_b16 v[98:99], v169 offset:5792
    ds_read_b64_tr_b16 v[100:101], v169 offset:5184
    ds_read_b64_tr_b16 v[102:103], v169 offset:5824
    ds_read_b64_tr_b16 v[104:105], v169 offset:5216
    ds_read_b64_tr_b16 v[106:107], v169 offset:5856
    ds_read_b64_tr_b16 v[108:109], v169 offset:5248
    ds_read_b64_tr_b16 v[110:111], v169 offset:5888
    s_waitcnt lgkmcnt(0)
    s_barrier
    v_add_u32 v168, 36864, v14
    v_add_u32 v169, 36864, v15
    ds_read_b128 v[112:115], v168 offset:0
    ds_read_b128 v[116:119], v168 offset:2048
    ds_read_b64_tr_b16 v[120:121], v169 offset:0
    ds_read_b64_tr_b16 v[122:123], v169 offset:640
    ds_read_b64_tr_b16 v[124:125], v169 offset:32
    ds_read_b64_tr_b16 v[126:127], v169 offset:672
    ds_read_b64_tr_b16 v[128:129], v169 offset:64
    ds_read_b64_tr_b16 v[130:131], v169 offset:704
    ds_read_b64_tr_b16 v[132:133], v169 offset:96
    ds_read_b64_tr_b16 v[134:135], v169 offset:736
    ds_read_b64_tr_b16 v[136:137], v169 offset:128
    ds_read_b64_tr_b16 v[138:139], v169 offset:768
    v_xor_b32 v168, 64, v168
    ds_read_b128 v[140:143], v168 offset:0
    ds_read_b128 v[144:147], v168 offset:2048
    ds_read_b64_tr_b16 v[148:149], v169 offset:5120
    ds_read_b64_tr_b16 v[150:151], v169 offset:5760
    ds_read_b64_tr_b16 v[152:153], v169 offset:5152
    ds_read_b64_tr_b16 v[154:155], v169 offset:5792
    ds_read_b64_tr_b16 v[156:157], v169 offset:5184
    ds_read_b64_tr_b16 v[158:159], v169 offset:5824
    ds_read_b64_tr_b16 v[160:161], v169 offset:5216
    ds_read_b64_tr_b16 v[162:163], v169 offset:5856
    ds_read_b64_tr_b16 v[164:165], v169 offset:5248
    ds_read_b64_tr_b16 v[166:167], v169 offset:5888
    v_mfma_f32_16x16x32_bf16 v[16:19], v[64:67], v[56:59], v[16:19]
    v_mfma_f32_16x16x32_bf16 v[20:23], v[64:67], v[60:63], v[20:23]
    v_mfma_f32_16x16x32_bf16 v[24:27], v[68:71], v[56:59], v[24:27]
    v_mfma_f32_16x16x32_bf16 v[28:31], v[68:71], v[60:63], v[28:31]
    v_mfma_f32_16x16x32_bf16 v[32:35], v[72:75], v[56:59], v[32:35]
    v_mfma_f32_16x16x32_bf16 v[36:39], v[72:75], v[60:63], v[36:39]
    v_mfma_f32_16x16x32_bf16 v[40:43], v[76:79], v[56:59], v[40:43]
    v_mfma_f32_16x16x32_bf16 v[44:47], v[76:79], v[60:63], v[44:47]
    v_mfma_f32_16x16x32_bf16 v[48:51], v[80:83], v[56:59], v[48:51]
    v_mfma_f32_16x16x32_bf16 v[52:55], v[80:83], v[60:63], v[52:55]
    v_mfma_f32_16x16x32_bf16 v[16:19], v[92:95], v[84:87], v[16:19]
    v_mfma_f32_16x16x32_bf16 v[20:23], v[92:95], v[88:91], v[20:23]
    v_mfma_f32_16x16x32_bf16 v[24:27], v[96:99], v[84:87], v[24:27]
    v_mfma_f32_16x16x32_bf16 v[28:31], v[96:99], v[88:91], v[28:31]
    v_mfma_f32_16x16x32_bf16 v[32:35], v[100:103], v[84:87], v[32:35]
    v_mfma_f32_16x16x32_bf16 v[36:39], v[100:103], v[88:91], v[36:39]
    v_mfma_f32_16x16x32_bf16 v[40:43], v[104:107], v[84:87], v[40:43]
    v_mfma_f32_16x16x32_bf16 v[44:47], v[104:107], v[88:91], v[44:47]
    v_mfma_f32_16x16x32_bf16 v[48:51], v[108:111], v[84:87], v[48:51]
    v_mfma_f32_16x16x32_bf16 v[52:55], v[108:111], v[88:91], v[52:55]
    s_waitcnt lgkmcnt(0)
    s_barrier
    v_add_u32 v168, 73728, v14
    v_add_u32 v169, 73728, v15
    ds_read_b128 v[56:59], v168 offset:0
    ds_read_b128 v[60:63], v168 offset:2048
    ds_read_b64_tr_b16 v[64:65], v169 offset:0
    ds_read_b64_tr_b16 v[66:67], v169 offset:640
    ds_read_b64_tr_b16 v[68:69], v169 offset:32
    ds_read_b64_tr_b16 v[70:71], v169 offset:672
    ds_read_b64_tr_b16 v[72:73], v169 offset:64
    ds_read_b64_tr_b16 v[74:75], v169 offset:704
    ds_read_b64_tr_b16 v[76:77], v169 offset:96
    ds_read_b64_tr_b16 v[78:79], v169 offset:736
    ds_read_b64_tr_b16 v[80:81], v169 offset:128
    ds_read_b64_tr_b16 v[82:83], v169 offset:768
    v_xor_b32 v168, 64, v168
    ds_read_b128 v[84:87], v168 offset:0
    ds_read_b128 v[88:91], v168 offset:2048
    ds_read_b64_tr_b16 v[92:93], v169 offset:5120
    ds_read_b64_tr_b16 v[94:95], v169 offset:5760
    ds_read_b64_tr_b16 v[96:97], v169 offset:5152
    ds_read_b64_tr_b16 v[98:99], v169 offset:5792
    ds_read_b64_tr_b16 v[100:101], v169 offset:5184
    ds_read_b64_tr_b16 v[102:103], v169 offset:5824
    ds_read_b64_tr_b16 v[104:105], v169 offset:5216
    ds_read_b64_tr_b16 v[106:107], v169 offset:5856
    ds_read_b64_tr_b16 v[108:109], v169 offset:5248
    ds_read_b64_tr_b16 v[110:111], v169 offset:5888
    v_mfma_f32_16x16x32_bf16 v[16:19], v[120:123], v[112:115], v[16:19]
    v_mfma_f32_16x16x32_bf16 v[20:23], v[120:123], v[116:119], v[20:23]
    v_mfma_f32_16x16x32_bf16 v[24:27], v[124:127], v[112:115], v[24:27]
    v_mfma_f32_16x16x32_bf16 v[28:31], v[124:127], v[116:119], v[28:31]
    v_mfma_f32_16x16x32_bf16 v[32:35], v[128:131], v[112:115], v[32:35]
    v_mfma_f32_16x16x32_bf16 v[36:39], v[128:131], v[116:119], v[36:39]
    v_mfma_f32_16x16x32_bf16 v[40:43], v[132:135], v[112:115], v[40:43]
    v_mfma_f32_16x16x32_bf16 v[44:47], v[132:135], v[116:119], v[44:47]
    v_mfma_f32_16x16x32_bf16 v[48:51], v[136:139], v[112:115], v[48:51]
    v_mfma_f32_16x16x32_bf16 v[52:55], v[136:139], v[116:119], v[52:55]
    v_mfma_f32_16x16x32_bf16 v[16:19], v[148:151], v[140:143], v[16:19]
    v_mfma_f32_16x16x32_bf16 v[20:23], v[148:151], v[144:147], v[20:23]
    v_mfma_f32_16x16x32_bf16 v[24:27], v[152:155], v[140:143], v[24:27]
    v_mfma_f32_16x16x32_bf16 v[28:31], v[152:155], v[144:147], v[28:31]
    v_mfma_f32_16x16x32_bf16 v[32:35], v[156:159], v[140:143], v[32:35]
    v_mfma_f32_16x16x32_bf16 v[36:39], v[156:159], v[144:147], v[36:39]
    v_mfma_f32_16x16x32_bf16 v[40:43], v[160:163], v[140:143], v[40:43]
    v_mfma_f32_16x16x32_bf16 v[44:47], v[160:163], v[144:147], v[44:47]
    v_mfma_f32_16x16x32_bf16 v[48:51], v[164:167], v[140:143], v[48:51]
    v_mfma_f32_16x16x32_bf16 v[52:55], v[164:167], v[144:147], v[52:55]
    s_waitcnt lgkmcnt(0)
    s_barrier
    v_add_u32 v168, 110592, v14
    v_add_u32 v169, 110592, v15
    ds_read_b128 v[112:115], v168 offset:0
    ds_read_b128 v[116:119], v168 offset:2048
    ds_read_b64_tr_b16 v[120:121], v169 offset:0
    ds_read_b64_tr_b16 v[122:123], v169 offset:640
    ds_read_b64_tr_b16 v[124:125], v169 offset:32
    ds_read_b64_tr_b16 v[126:127], v169 offset:672
    ds_read_b64_tr_b16 v[128:129], v169 offset:64
    ds_read_b64_tr_b16 v[130:131], v169 offset:704
    ds_read_b64_tr_b16 v[132:133], v169 offset:96
    ds_read_b64_tr_b16 v[134:135], v169 offset:736
    ds_read_b64_tr_b16 v[136:137], v169 offset:128
    ds_read_b64_tr_b16 v[138:139], v169 offset:768
    v_xor_b32 v168, 64, v168
    ds_read_b128 v[140:143], v168 offset:0
    ds_read_b128 v[144:147], v168 offset:2048
    ds_read_b64_tr_b16 v[148:149], v169 offset:5120
    ds_read_b64_tr_b16 v[150:151], v169 offset:5760
    ds_read_b64_tr_b16 v[152:153], v169 offset:5152
    ds_read_b64_tr_b16 v[154:155], v169 offset:5792
    ds_read_b64_tr_b16 v[156:157], v169 offset:5184
    ds_read_b64_tr_b16 v[158:159], v169 offset:5824
    ds_read_b64_tr_b16 v[160:161], v169 offset:5216
    ds_read_b64_tr_b16 v[162:163], v169 offset:5856
    ds_read_b64_tr_b16 v[164:165], v169 offset:5248
    ds_read_b64_tr_b16 v[166:167], v169 offset:5888
    v_mfma_f32_16x16x32_bf16 v[16:19], v[64:67], v[56:59], v[16:19]
    v_mfma_f32_16x16x32_bf16 v[20:23], v[64:67], v[60:63], v[20:23]
    v_mfma_f32_16x16x32_bf16 v[24:27], v[68:71], v[56:59], v[24:27]
    v_mfma_f32_16x16x32_bf16 v[28:31], v[68:71], v[60:63], v[28:31]
    v_mfma_f32_16x16x32_bf16 v[32:35], v[72:75], v[56:59], v[32:35]
    v_mfma_f32_16x16x32_bf16 v[36:39], v[72:75], v[60:63], v[36:39]
    v_mfma_f32_16x16x32_bf16 v[40:43], v[76:79], v[56:59], v[40:43]
    v_mfma_f32_16x16x32_bf16 v[44:47], v[76:79], v[60:63], v[44:47]
    v_mfma_f32_16x16x32_bf16 v[48:51], v[80:83], v[56:59], v[48:51]
    v_mfma_f32_16x16x32_bf16 v[52:55], v[80:83], v[60:63], v[52:55]
    v_mfma_f32_16x16x32_bf16 v[16:19], v[92:95], v[84:87], v[16:19]
    v_mfma_f32_16x16x32_bf16 v[20:23], v[92:95], v[88:91], v[20:23]
    v_mfma_f32_16x16x32_bf16 v[24:27], v[96:99], v[84:87], v[24:27]
    v_mfma_f32_16x16x32_bf16 v[28:31], v[96:99], v[88:91], v[28:31]
    v_mfma_f32_16x16x32_bf16 v[32:35], v[100:103], v[84:87], v[32:35]
    v_mfma_f32_16x16x32_bf16 v[36:39], v[100:103], v[88:91], v[36:39]
    v_mfma_f32_16x16x32_bf16 v[40:43], v[104:107], v[84:87], v[40:43]
    v_mfma_f32_16x16x32_bf16 v[44:47], v[104:107], v[88:91], v[44:47]
    v_mfma_f32_16x16x32_bf16 v[48:51], v[108:111], v[84:87], v[48:51]
    v_mfma_f32_16x16x32_bf16 v[52:55], v[108:111], v[88:91], v[52:55]
    s_waitcnt lgkmcnt(0)
    s_barrier
    v_add_u32 v168, 0, v14
    v_add_u32 v169, 0, v15
    ds_read_b128 v[56:59], v168 offset:0
    ds_read_b128 v[60:63], v168 offset:2048
    ds_read_b64_tr_b16 v[64:65], v169 offset:0
    ds_read_b64_tr_b16 v[66:67], v169 offset:640
    ds_read_b64_tr_b16 v[68:69], v169 offset:32
    ds_read_b64_tr_b16 v[70:71], v169 offset:672
    ds_read_b64_tr_b16 v[72:73], v169 offset:64
    ds_read_b64_tr_b16 v[74:75], v169 offset:704
    ds_read_b64_tr_b16 v[76:77], v169 offset:96
    ds_read_b64_tr_b16 v[78:79], v169 offset:736
    ds_read_b64_tr_b16 v[80:81], v169 offset:128
    ds_read_b64_tr_b16 v[82:83], v169 offset:768
    v_xor_b32 v168, 64, v168
    ds_read_b128 v[84:87], v168 offset:0
    ds_read_b128 v[88:91], v168 offset:2048
    ds_read_b64_tr_b16 v[92:93], v169 offset:5120
    ds_read_b64_tr_b16 v[94:95], v169 offset:5760
    ds_read_b64_tr_b16 v[96:97], v169 offset:5152
    ds_read_b64_tr_b16 v[98:99], v169 offset:5792
    ds_read_b64_tr_b16 v[100:101], v169 offset:5184
    ds_read_b64_tr_b16 v[102:103], v169 offset:5824
    ds_read_b64_tr_b16 v[104:105], v169 offset:5216
    ds_read_b64_tr_b16 v[106:107], v169 offset:5856
    ds_read_b64_tr_b16 v[108:109], v169 offset:5248
    ds_read_b64_tr_b16 v[110:111], v169 offset:5888
    v_mfma_f32_16x16x32_bf16 v[16:19], v[120:123], v[112:115], v[16:19]
    v_mfma_f32_16x16x32_bf16 v[20:23], v[120:123], v[116:119], v[20:23]
    v_mfma_f32_16x16x32_bf16 v[24:27], v[124:127], v[112:115], v[24:27]
    v_mfma_f32_16x16x32_bf16 v[28:31], v[124:127], v[116:119], v[28:31]
    v_mfma_f32_16x16x32_bf16 v[32:35], v[128:131], v[112:115], v[32:35]
    v_mfma_f32_16x16x32_bf16 v[36:39], v[128:131], v[116:119], v[36:39]
    v_mfma_f32_16x16x32_bf16 v[40:43], v[132:135], v[112:115], v[40:43]
    v_mfma_f32_16x16x32_bf16 v[44:47], v[132:135], v[116:119], v[44:47]
    v_mfma_f32_16x16x32_bf16 v[48:51], v[136:139], v[112:115], v[48:51]
    v_mfma_f32_16x16x32_bf16 v[52:55], v[136:139], v[116:119], v[52:55]
    v_mfma_f32_16x16x32_bf16 v[16:19], v[148:151], v[140:143], v[16:19]
    v_mfma_f32_16x16x32_bf16 v[20:23], v[148:151], v[144:147], v[20:23]
    v_mfma_f32_16x16x32_bf16 v[24:27], v[152:155], v[140:143], v[24:27]
    v_mfma_f32_16x16x32_bf16 v[28:31], v[152:155], v[144:147], v[28:31]
    v_mfma_f32_16x16x32_bf16 v[32:35], v[156:159], v[140:143], v[32:35]
    v_mfma_f32_16x16x32_bf16 v[36:39], v[156:159], v[144:147], v[36:39]
    v_mfma_f32_16x16x32_bf16 v[40:43], v[160:163], v[140:143], v[40:43]
    v_mfma_f32_16x16x32_bf16 v[44:47], v[160:163], v[144:147], v[44:47]
    v_mfma_f32_16x16x32_bf16 v[48:51], v[164:167], v[140:143], v[48:51]
    v_mfma_f32_16x16x32_bf16 v[52:55], v[164:167], v[144:147], v[52:55]
    s_waitcnt lgkmcnt(0)
    s_barrier
    v_add_u32 v168, 36864, v14
    v_add_u32 v169, 36864, v15
    ds_read_b128 v[112:115], v168 offset:0
    ds_read_b128 v[116:119], v168 offset:2048
    ds_read_b64_tr_b16 v[120:121], v169 offset:0
    ds_read_b64_tr_b16 v[122:123], v169 offset:640
    ds_read_b64_tr_b16 v[124:125], v169 offset:32
    ds_read_b64_tr_b16 v[126:127], v169 offset:672
    ds_read_b64_tr_b16 v[128:129], v169 offset:64
    ds_read_b64_tr_b16 v[130:131], v169 offset:704
    ds_read_b64_tr_b16 v[132:133], v169 offset:96
    ds_read_b64_tr_b16 v[134:135], v169 offset:736
    ds_read_b64_tr_b16 v[136:137], v169 offset:128
    ds_read_b64_tr_b16 v[138:139], v169 offset:768
    v_xor_b32 v168, 64, v168
    ds_read_b128 v[140:143], v168 offset:0
    ds_read_b128 v[144:147], v168 offset:2048
    ds_read_b64_tr_b16 v[148:149], v169 offset:5120
    ds_read_b64_tr_b16 v[150:151], v169 offset:5760
    ds_read_b64_tr_b16 v[152:153], v169 offset:5152
    ds_read_b64_tr_b16 v[154:155], v169 offset:5792
    ds_read_b64_tr_b16 v[156:157], v169 offset:5184
    ds_read_b64_tr_b16 v[158:159], v169 offset:5824
    ds_read_b64_tr_b16 v[160:161], v169 offset:5216
    ds_read_b64_tr_b16 v[162:163], v169 offset:5856
    ds_read_b64_tr_b16 v[164:165], v169 offset:5248
    ds_read_b64_tr_b16 v[166:167], v169 offset:5888
    v_mfma_f32_16x16x32_bf16 v[16:19], v[64:67], v[56:59], v[16:19]
    v_mfma_f32_16x16x32_bf16 v[20:23], v[64:67], v[60:63], v[20:23]
    v_mfma_f32_16x16x32_bf16 v[24:27], v[68:71], v[56:59], v[24:27]
    v_mfma_f32_16x16x32_bf16 v[28:31], v[68:71], v[60:63], v[28:31]
    v_mfma_f32_16x16x32_bf16 v[32:35], v[72:75], v[56:59], v[32:35]
    v_mfma_f32_16x16x32_bf16 v[36:39], v[72:75], v[60:63], v[36:39]
    v_mfma_f32_16x16x32_bf16 v[40:43], v[76:79], v[56:59], v[40:43]
    v_mfma_f32_16x16x32_bf16 v[44:47], v[76:79], v[60:63], v[44:47]
    v_mfma_f32_16x16x32_bf16 v[48:51], v[80:83], v[56:59], v[48:51]
    v_mfma_f32_16x16x32_bf16 v[52:55], v[80:83], v[60:63], v[52:55]
    v_mfma_f32_16x16x32_bf16 v[16:19], v[92:95], v[84:87], v[16:19]
    v_mfma_f32_16x16x32_bf16 v[20:23], v[92:95], v[88:91], v[20:23]
    v_mfma_f32_16x16x32_bf16 v[24:27], v[96:99], v[84:87], v[24:27]
    v_mfma_f32_16x16x32_bf16 v[28:31], v[96:99], v[88:91], v[28:31]
    v_mfma_f32_16x16x32_bf16 v[32:35], v[100:103], v[84:87], v[32:35]
    v_mfma_f32_16x16x32_bf16 v[36:39], v[100:103], v[88:91], v[36:39]
    v_mfma_f32_16x16x32_bf16 v[40:43], v[104:107], v[84:87], v[40:43]
    v_mfma_f32_16x16x32_bf16 v[44:47], v[104:107], v[88:91], v[44:47]
    v_mfma_f32_16x16x32_bf16 v[48:51], v[108:111], v[84:87], v[48:51]
    v_mfma_f32_16x16x32_bf16 v[52:55], v[108:111], v[88:91], v[52:55]
    s_waitcnt lgkmcnt(0)
    s_barrier
    v_add_u32 v168, 73728, v14
    v_add_u32 v169, 73728, v15
    ds_read_b128 v[56:59], v168 offset:0
    ds_read_b128 v[60:63], v168 offset:2048
    ds_read_b64_tr_b16 v[64:65], v169 offset:0
    ds_read_b64_tr_b16 v[66:67], v169 offset:640
    ds_read_b64_tr_b16 v[68:69], v169 offset:32
    ds_read_b64_tr_b16 v[70:71], v169 offset:672
    ds_read_b64_tr_b16 v[72:73], v169 offset:64
    ds_read_b64_tr_b16 v[74:75], v169 offset:704
    ds_read_b64_tr_b16 v[76:77], v169 offset:96
    ds_read_b64_tr_b16 v[78:79], v169 offset:736
    ds_read_b64_tr_b16 v[80:81], v169 offset:128
    ds_read_b64_tr_b16 v[82:83], v169 offset:768
    v_xor_b32 v168, 64, v168
    ds_read_b128 v[84:87], v168 offset:0
    ds_read_b128 v[88:91], v168 offset:2048
    ds_read_b64_tr_b16 v[92:93], v169 offset:5120
    ds_read_b64_tr_b16 v[94:95], v169 offset:5760
    ds_read_b64_tr_b16 v[96:97], v169 offset:5152
    ds_read_b64_tr_b16 v[98:99], v169 offset:5792
    ds_read_b64_tr_b16 v[100:101], v169 offset:5184
    ds_read_b64_tr_b16 v[102:103], v169 offset:5824
    ds_read_b64_tr_b16 v[104:105], v169 offset:5216
    ds_read_b64_tr_b16 v[106:107], v169 offset:5856
    ds_read_b64_tr_b16 v[108:109], v169 offset:5248
    ds_read_b64_tr_b16 v[110:111], v169 offset:5888
    v_mfma_f32_16x16x32_bf16 v[16:19], v[120:123], v[112:115], v[16:19]
    v_mfma_f32_16x16x32_bf16 v[20:23], v[120:123], v[116:119], v[20:23]
    v_mfma_f32_16x16x32_bf16 v[24:27], v[124:127], v[112:115], v[24:27]
    v_mfma_f32_16x16x32_bf16 v[28:31], v[124:127], v[116:119], v[28:31]
    v_mfma_f32_16x16x32_bf16 v[32:35], v[128:131], v[112:115], v[32:35]
    v_mfma_f32_16x16x32_bf16 v[36:39], v[128:131], v[116:119], v[36:39]
    v_mfma_f32_16x16x32_bf16 v[40:43], v[132:135], v[112:115], v[40:43]
    v_mfma_f32_16x16x32_bf16 v[44:47], v[132:135], v[116:119], v[44:47]
    v_mfma_f32_16x16x32_bf16 v[48:51], v[136:139], v[112:115], v[48:51]
    v_mfma_f32_16x16x32_bf16 v[52:55], v[136:139], v[116:119], v[52:55]
    v_mfma_f32_16x16x32_bf16 v[16:19], v[148:151], v[140:143], v[16:19]
    v_mfma_f32_16x16x32_bf16 v[20:23], v[148:151], v[144:147], v[20:23]
    v_mfma_f32_16x16x32_bf16 v[24:27], v[152:155], v[140:143], v[24:27]
    v_mfma_f32_16x16x32_bf16 v[28:31], v[152:155], v[144:147], v[28:31]
    v_mfma_f32_16x16x32_bf16 v[32:35], v[156:159], v[140:143], v[32:35]
    v_mfma_f32_16x16x32_bf16 v[36:39], v[156:159], v[144:147], v[36:39]
    v_mfma_f32_16x16x32_bf16 v[40:43], v[160:163], v[140:143], v[40:43]
    v_mfma_f32_16x16x32_bf16 v[44:47], v[160:163], v[144:147], v[44:47]
    v_mfma_f32_16x16x32_bf16 v[48:51], v[164:167], v[140:143], v[48:51]
    v_mfma_f32_16x16x32_bf16 v[52:55], v[164:167], v[144:147], v[52:55]
    s_waitcnt lgkmcnt(0)
    s_barrier
    v_add_u32 v168, 110592, v14
    v_add_u32 v169, 110592, v15
    ds_read_b128 v[112:115], v168 offset:0
    ds_read_b128 v[116:119], v168 offset:2048
    ds_read_b64_tr_b16 v[120:121], v169 offset:0
    ds_read_b64_tr_b16 v[122:123], v169 offset:640
    ds_read_b64_tr_b16 v[124:125], v169 offset:32
    ds_read_b64_tr_b16 v[126:127], v169 offset:672
    ds_read_b64_tr_b16 v[128:129], v169 offset:64
    ds_read_b64_tr_b16 v[130:131], v169 offset:704
    ds_read_b64_tr_b16 v[132:133], v169 offset:96
    ds_read_b64_tr_b16 v[134:135], v169 offset:736
    ds_read_b64_tr_b16 v[136:137], v169 offset:128
    ds_read_b64_tr_b16 v[138:139], v169 offset:768
    v_xor_b32 v168, 64, v168
    ds_read_b128 v[140:143], v168 offset:0
    ds_read_b128 v[144:147], v168 offset:2048
    ds_read_b64_tr_b16 v[148:149], v169 offset:5120
    ds_read_b64_tr_b16 v[150:151], v169 offset:5760
    ds_read_b64_tr_b16 v[152:153], v169 offset:5152
    ds_read_b64_tr_b16 v[154:155], v169 offset:5792
    ds_read_b64_tr_b16 v[156:157], v169 offset:5184
    ds_read_b64_tr_b16 v[158:159], v169 offset:5824
    ds_read_b64_tr_b16 v[160:161], v169 offset:5216
    ds_read_b64_tr_b16 v[162:163], v169 offset:5856
    ds_read_b64_tr_b16 v[164:165], v169 offset:5248
    ds_read_b64_tr_b16 v[166:167], v169 offset:5888
    v_mfma_f32_16x16x32_bf16 v[16:19], v[64:67], v[56:59], v[16:19]
    v_mfma_f32_16x16x32_bf16 v[20:23], v[64:67], v[60:63], v[20:23]
    v_mfma_f32_16x16x32_bf16 v[24:27], v[68:71], v[56:59], v[24:27]
    v_mfma_f32_16x16x32_bf16 v[28:31], v[68:71], v[60:63], v[28:31]
    v_mfma_f32_16x16x32_bf16 v[32:35], v[72:75], v[56:59], v[32:35]
    v_mfma_f32_16x16x32_bf16 v[36:39], v[72:75], v[60:63], v[36:39]
    v_mfma_f32_16x16x32_bf16 v[40:43], v[76:79], v[56:59], v[40:43]
    v_mfma_f32_16x16x32_bf16 v[44:47], v[76:79], v[60:63], v[44:47]
    v_mfma_f32_16x16x32_bf16 v[48:51], v[80:83], v[56:59], v[48:51]
    v_mfma_f32_16x16x32_bf16 v[52:55], v[80:83], v[60:63], v[52:55]
    v_mfma_f32_16x16x32_bf16 v[16:19], v[92:95], v[84:87], v[16:19]
    v_mfma_f32_16x16x32_bf16 v[20:23], v[92:95], v[88:91], v[20:23]
    v_mfma_f32_16x16x32_bf16 v[24:27], v[96:99], v[84:87], v[24:27]
    v_mfma_f32_16x16x32_bf16 v[28:31], v[96:99], v[88:91], v[28:31]
    v_mfma_f32_16x16x32_bf16 v[32:35], v[100:103], v[84:87], v[32:35]
    v_mfma_f32_16x16x32_bf16 v[36:39], v[100:103], v[88:91], v[36:39]
    v_mfma_f32_16x16x32_bf16 v[40:43], v[104:107], v[84:87], v[40:43]
    v_mfma_f32_16x16x32_bf16 v[44:47], v[104:107], v[88:91], v[44:47]
    v_mfma_f32_16x16x32_bf16 v[48:51], v[108:111], v[84:87], v[48:51]
    v_mfma_f32_16x16x32_bf16 v[52:55], v[108:111], v[88:91], v[52:55]
    s_waitcnt lgkmcnt(0)
    s_barrier
    v_add_u32 v168, 0, v14
    v_add_u32 v169, 0, v15
    ds_read_b128 v[56:59], v168 offset:0
    ds_read_b128 v[60:63], v168 offset:2048
    ds_read_b64_tr_b16 v[64:65], v169 offset:0
    ds_read_b64_tr_b16 v[66:67], v169 offset:640
    ds_read_b64_tr_b16 v[68:69], v169 offset:32
    ds_read_b64_tr_b16 v[70:71], v169 offset:672
    ds_read_b64_tr_b16 v[72:73], v169 offset:64
    ds_read_b64_tr_b16 v[74:75], v169 offset:704
    ds_read_b64_tr_b16 v[76:77], v169 offset:96
    ds_read_b64_tr_b16 v[78:79], v169 offset:736
    ds_read_b64_tr_b16 v[80:81], v169 offset:128
    ds_read_b64_tr_b16 v[82:83], v169 offset:768
    v_xor_b32 v168, 64, v168
    ds_read_b128 v[84:87], v168 offset:0
    ds_read_b128 v[88:91], v168 offset:2048
    ds_read_b64_tr_b16 v[92:93], v169 offset:5120
    ds_read_b64_tr_b16 v[94:95], v169 offset:5760
    ds_read_b64_tr_b16 v[96:97], v169 offset:5152
    ds_read_b64_tr_b16 v[98:99], v169 offset:5792
    ds_read_b64_tr_b16 v[100:101], v169 offset:5184
    ds_read_b64_tr_b16 v[102:103], v169 offset:5824
    ds_read_b64_tr_b16 v[104:105], v169 offset:5216
    ds_read_b64_tr_b16 v[106:107], v169 offset:5856
    ds_read_b64_tr_b16 v[108:109], v169 offset:5248
    ds_read_b64_tr_b16 v[110:111], v169 offset:5888
    v_mfma_f32_16x16x32_bf16 v[16:19], v[120:123], v[112:115], v[16:19]
    v_mfma_f32_16x16x32_bf16 v[20:23], v[120:123], v[116:119], v[20:23]
    v_mfma_f32_16x16x32_bf16 v[24:27], v[124:127], v[112:115], v[24:27]
    v_mfma_f32_16x16x32_bf16 v[28:31], v[124:127], v[116:119], v[28:31]
    v_mfma_f32_16x16x32_bf16 v[32:35], v[128:131], v[112:115], v[32:35]
    v_mfma_f32_16x16x32_bf16 v[36:39], v[128:131], v[116:119], v[36:39]
    v_mfma_f32_16x16x32_bf16 v[40:43], v[132:135], v[112:115], v[40:43]
    v_mfma_f32_16x16x32_bf16 v[44:47], v[132:135], v[116:119], v[44:47]
    v_mfma_f32_16x16x32_bf16 v[48:51], v[136:139], v[112:115], v[48:51]
    v_mfma_f32_16x16x32_bf16 v[52:55], v[136:139], v[116:119], v[52:55]
    v_mfma_f32_16x16x32_bf16 v[16:19], v[148:151], v[140:143], v[16:19]
    v_mfma_f32_16x16x32_bf16 v[20:23], v[148:151], v[144:147], v[20:23]
    v_mfma_f32_16x16x32_bf16 v[24:27], v[152:155], v[140:143], v[24:27]
    v_mfma_f32_16x16x32_bf16 v[28:31], v[152:155], v[144:147], v[28:31]
    v_mfma_f32_16x16x32_bf16 v[32:35], v[156:159], v[140:143], v[32:35]
    v_mfma_f32_16x16x32_bf16 v[36:39], v[156:159], v[144:147], v[36:39]
    v_mfma_f32_16x16x32_bf16 v[40:43], v[160:163], v[140:143], v[40:43]
    v_mfma_f32_16x16x32_bf16 v[44:47], v[160:163], v[144:147], v[44:47]
    v_mfma_f32_16x16x32_bf16 v[48:51], v[164:167], v[140:143], v[48:51]
    v_mfma_f32_16x16x32_bf16 v[52:55], v[164:167], v[144:147], v[52:55]
    s_waitcnt lgkmcnt(0)
    s_barrier
    v_add_u32 v168, 36864, v14
    v_add_u32 v169, 36864, v15
    ds_read_b128 v[112:115], v168 offset:0
    ds_read_b128 v[116:119], v168 offset:2048
    ds_read_b64_tr_b16 v[120:121], v169 offset:0
    ds_read_b64_tr_b16 v[122:123], v169 offset:640
    ds_read_b64_tr_b16 v[124:125], v169 offset:32
    ds_read_b64_tr_b16 v[126:127], v169 offset:672
    ds_read_b64_tr_b16 v[128:129], v169 offset:64
    ds_read_b64_tr_b16 v[130:131], v169 offset:704
    ds_read_b64_tr_b16 v[132:133], v169 offset:96
    ds_read_b64_tr_b16 v[134:135], v169 offset:736
    ds_read_b64_tr_b16 v[136:137], v169 offset:128
    ds_read_b64_tr_b16 v[138:139], v169 offset:768
    v_xor_b32 v168, 64, v168
    ds_read_b128 v[140:143], v168 offset:0
    ds_read_b128 v[144:147], v168 offset:2048
    ds_read_b64_tr_b16 v[148:149], v169 offset:5120
    ds_read_b64_tr_b16 v[150:151], v169 offset:5760
    ds_read_b64_tr_b16 v[152:153], v169 offset:5152
    ds_read_b64_tr_b16 v[154:155], v169 offset:5792
    ds_read_b64_tr_b16 v[156:157], v169 offset:5184
    ds_read_b64_tr_b16 v[158:159], v169 offset:5824
    ds_read_b64_tr_b16 v[160:161], v169 offset:5216
    ds_read_b64_tr_b16 v[162:163], v169 offset:5856
    ds_read_b64_tr_b16 v[164:165], v169 offset:5248
    ds_read_b64_tr_b16 v[166:167], v169 offset:5888
    v_mfma_f32_16x16x32_bf16 v[16:19], v[64:67], v[56:59], v[16:19]
    v_mfma_f32_16x16x32_bf16 v[20:23], v[64:67], v[60:63], v[20:23]
    v_mfma_f32_16x16x32_bf16 v[24:27], v[68:71], v[56:59], v[24:27]
    v_mfma_f32_16x16x32_bf16 v[28:31], v[68:71], v[60:63], v[28:31]
    v_mfma_f32_16x16x32_bf16 v[32:35], v[72:75], v[56:59], v[32:35]
    v_mfma_f32_16x16x32_bf16 v[36:39], v[72:75], v[60:63], v[36:39]
    v_mfma_f32_16x16x32_bf16 v[40:43], v[76:79], v[56:59], v[40:43]
    v_mfma_f32_16x16x32_bf16 v[44:47], v[76:79], v[60:63], v[44:47]
    v_mfma_f32_16x16x32_bf16 v[48:51], v[80:83], v[56:59], v[48:51]
    v_mfma_f32_16x16x32_bf16 v[52:55], v[80:83], v[60:63], v[52:55]
    v_mfma_f32_16x16x32_bf16 v[16:19], v[92:95], v[84:87], v[16:19]
    v_mfma_f32_16x16x32_bf16 v[20:23], v[92:95], v[88:91], v[20:23]
    v_mfma_f32_16x16x32_bf16 v[24:27], v[96:99], v[84:87], v[24:27]
    v_mfma_f32_16x16x32_bf16 v[28:31], v[96:99], v[88:91], v[28:31]
    v_mfma_f32_16x16x32_bf16 v[32:35], v[100:103], v[84:87], v[32:35]
    v_mfma_f32_16x16x32_bf16 v[36:39], v[100:103], v[88:91], v[36:39]
    v_mfma_f32_16x16x32_bf16 v[40:43], v[104:107], v[84:87], v[40:43]
    v_mfma_f32_16x16x32_bf16 v[44:47], v[104:107], v[88:91], v[44:47]
    v_mfma_f32_16x16x32_bf16 v[48:51], v[108:111], v[84:87], v[48:51]
    v_mfma_f32_16x16x32_bf16 v[52:55], v[108:111], v[88:91], v[52:55]
    s_waitcnt lgkmcnt(0)
    s_barrier
    v_add_u32 v168, 73728, v14
    v_add_u32 v169, 73728, v15
    ds_read_b128 v[56:59], v168 offset:0
    ds_read_b128 v[60:63], v168 offset:2048
    ds_read_b64_tr_b16 v[64:65], v169 offset:0
    ds_read_b64_tr_b16 v[66:67], v169 offset:640
    ds_read_b64_tr_b16 v[68:69], v169 offset:32
    ds_read_b64_tr_b16 v[70:71], v169 offset:672
    ds_read_b64_tr_b16 v[72:73], v169 offset:64
    ds_read_b64_tr_b16 v[74:75], v169 offset:704
    ds_read_b64_tr_b16 v[76:77], v169 offset:96
    ds_read_b64_tr_b16 v[78:79], v169 offset:736
    ds_read_b64_tr_b16 v[80:81], v169 offset:128
    ds_read_b64_tr_b16 v[82:83], v169 offset:768
    v_xor_b32 v168, 64, v168
    ds_read_b128 v[84:87], v168 offset:0
    ds_read_b128 v[88:91], v168 offset:2048
    ds_read_b64_tr_b16 v[92:93], v169 offset:5120
    ds_read_b64_tr_b16 v[94:95], v169 offset:5760
    ds_read_b64_tr_b16 v[96:97], v169 offset:5152
    ds_read_b64_tr_b16 v[98:99], v169 offset:5792
    ds_read_b64_tr_b16 v[100:101], v169 offset:5184
    ds_read_b64_tr_b16 v[102:103], v169 offset:5824
    ds_read_b64_tr_b16 v[104:105], v169 offset:5216
    ds_read_b64_tr_b16 v[106:107], v169 offset:5856
    ds_read_b64_tr_b16 v[108:109], v169 offset:5248
    ds_read_b64_tr_b16 v[110:111], v169 offset:5888
    v_mfma_f32_16x16x32_bf16 v[16:19], v[120:123], v[112:115], v[16:19]
    v_mfma_f32_16x16x32_bf16 v[20:23], v[120:123], v[116:119], v[20:23]
    v_mfma_f32_16x16x32_bf16 v[24:27], v[124:127], v[112:115], v[24:27]
    v_mfma_f32_16x16x32_bf16 v[28:31], v[124:127], v[116:119], v[28:31]
    v_mfma_f32_16x16x32_bf16 v[32:35], v[128:131], v[112:115], v[32:35]
    v_mfma_f32_16x16x32_bf16 v[36:39], v[128:131], v[116:119], v[36:39]
    v_mfma_f32_16x16x32_bf16 v[40:43], v[132:135], v[112:115], v[40:43]
    v_mfma_f32_16x16x32_bf16 v[44:47], v[132:135], v[116:119], v[44:47]
    v_mfma_f32_16x16x32_bf16 v[48:51], v[136:139], v[112:115], v[48:51]
    v_mfma_f32_16x16x32_bf16 v[52:55], v[136:139], v[116:119], v[52:55]
    v_mfma_f32_16x16x32_bf16 v[16:19], v[148:151], v[140:143], v[16:19]
    v_mfma_f32_16x16x32_bf16 v[20:23], v[148:151], v[144:147], v[20:23]
    v_mfma_f32_16x16x32_bf16 v[24:27], v[152:155], v[140:143], v[24:27]
    v_mfma_f32_16x16x32_bf16 v[28:31], v[152:155], v[144:147], v[28:31]
    v_mfma_f32_16x16x32_bf16 v[32:35], v[156:159], v[140:143], v[32:35]
    v_mfma_f32_16x16x32_bf16 v[36:39], v[156:159], v[144:147], v[36:39]
    v_mfma_f32_16x16x32_bf16 v[40:43], v[160:163], v[140:143], v[40:43]
    v_mfma_f32_16x16x32_bf16 v[44:47], v[160:163], v[144:147], v[44:47]
    v_mfma_f32_16x16x32_bf16 v[48:51], v[164:167], v[140:143], v[48:51]
    v_mfma_f32_16x16x32_bf16 v[52:55], v[164:167], v[144:147], v[52:55]
    s_waitcnt lgkmcnt(0)
    s_barrier
    v_add_u32 v168, 110592, v14
    v_add_u32 v169, 110592, v15
    ds_read_b128 v[112:115], v168 offset:0
    ds_read_b128 v[116:119], v168 offset:2048
    ds_read_b64_tr_b16 v[120:121], v169 offset:0
    ds_read_b64_tr_b16 v[122:123], v169 offset:640
    ds_read_b64_tr_b16 v[124:125], v169 offset:32
    ds_read_b64_tr_b16 v[126:127], v169 offset:672
    ds_read_b64_tr_b16 v[128:129], v169 offset:64
    ds_read_b64_tr_b16 v[130:131], v169 offset:704
    ds_read_b64_tr_b16 v[132:133], v169 offset:96
    ds_read_b64_tr_b16 v[134:135], v169 offset:736
    ds_read_b64_tr_b16 v[136:137], v169 offset:128
    ds_read_b64_tr_b16 v[138:139], v169 offset:768
    v_xor_b32 v168, 64, v168
    ds_read_b128 v[140:143], v168 offset:0
    ds_read_b128 v[144:147], v168 offset:2048
    ds_read_b64_tr_b16 v[148:149], v169 offset:5120
    ds_read_b64_tr_b16 v[150:151], v169 offset:5760
    ds_read_b64_tr_b16 v[152:153], v169 offset:5152
    ds_read_b64_tr_b16 v[154:155], v169 offset:5792
    ds_read_b64_tr_b16 v[156:157], v169 offset:5184
    ds_read_b64_tr_b16 v[158:159], v169 offset:5824
    ds_read_b64_tr_b16 v[160:161], v169 offset:5216
    ds_read_b64_tr_b16 v[162:163], v169 offset:5856
    ds_read_b64_tr_b16 v[164:165], v169 offset:5248
    ds_read_b64_tr_b16 v[166:167], v169 offset:5888
    v_mfma_f32_16x16x32_bf16 v[16:19], v[64:67], v[56:59], v[16:19]
    v_mfma_f32_16x16x32_bf16 v[20:23], v[64:67], v[60:63], v[20:23]
    v_mfma_f32_16x16x32_bf16 v[24:27], v[68:71], v[56:59], v[24:27]
    v_mfma_f32_16x16x32_bf16 v[28:31], v[68:71], v[60:63], v[28:31]
    v_mfma_f32_16x16x32_bf16 v[32:35], v[72:75], v[56:59], v[32:35]
    v_mfma_f32_16x16x32_bf16 v[36:39], v[72:75], v[60:63], v[36:39]
    v_mfma_f32_16x16x32_bf16 v[40:43], v[76:79], v[56:59], v[40:43]
    v_mfma_f32_16x16x32_bf16 v[44:47], v[76:79], v[60:63], v[44:47]
    v_mfma_f32_16x16x32_bf16 v[48:51], v[80:83], v[56:59], v[48:51]
    v_mfma_f32_16x16x32_bf16 v[52:55], v[80:83], v[60:63], v[52:55]
    v_mfma_f32_16x16x32_bf16 v[16:19], v[92:95], v[84:87], v[16:19]
    v_mfma_f32_16x16x32_bf16 v[20:23], v[92:95], v[88:91], v[20:23]
    v_mfma_f32_16x16x32_bf16 v[24:27], v[96:99], v[84:87], v[24:27]
    v_mfma_f32_16x16x32_bf16 v[28:31], v[96:99], v[88:91], v[28:31]
    v_mfma_f32_16x16x32_bf16 v[32:35], v[100:103], v[84:87], v[32:35]
    v_mfma_f32_16x16x32_bf16 v[36:39], v[100:103], v[88:91], v[36:39]
    v_mfma_f32_16x16x32_bf16 v[40:43], v[104:107], v[84:87], v[40:43]
    v_mfma_f32_16x16x32_bf16 v[44:47], v[104:107], v[88:91], v[44:47]
    v_mfma_f32_16x16x32_bf16 v[48:51], v[108:111], v[84:87], v[48:51]
    v_mfma_f32_16x16x32_bf16 v[52:55], v[108:111], v[88:91], v[52:55]
    s_waitcnt lgkmcnt(0)
    v_mfma_f32_16x16x32_bf16 v[16:19], v[120:123], v[112:115], v[16:19]
    v_mfma_f32_16x16x32_bf16 v[20:23], v[120:123], v[116:119], v[20:23]
    v_mfma_f32_16x16x32_bf16 v[24:27], v[124:127], v[112:115], v[24:27]
    v_mfma_f32_16x16x32_bf16 v[28:31], v[124:127], v[116:119], v[28:31]
    v_mfma_f32_16x16x32_bf16 v[32:35], v[128:131], v[112:115], v[32:35]
    v_mfma_f32_16x16x32_bf16 v[36:39], v[128:131], v[116:119], v[36:39]
    v_mfma_f32_16x16x32_bf16 v[40:43], v[132:135], v[112:115], v[40:43]
    v_mfma_f32_16x16x32_bf16 v[44:47], v[132:135], v[116:119], v[44:47]
    v_mfma_f32_16x16x32_bf16 v[48:51], v[136:139], v[112:115], v[48:51]
    v_mfma_f32_16x16x32_bf16 v[52:55], v[136:139], v[116:119], v[52:55]
    v_mfma_f32_16x16x32_bf16 v[16:19], v[148:151], v[140:143], v[16:19]
    v_mfma_f32_16x16x32_bf16 v[20:23], v[148:151], v[144:147], v[20:23]
    v_mfma_f32_16x16x32_bf16 v[24:27], v[152:155], v[140:143], v[24:27]
    v_mfma_f32_16x16x32_bf16 v[28:31], v[152:155], v[144:147], v[28:31]
    v_mfma_f32_16x16x32_bf16 v[32:35], v[156:159], v[140:143], v[32:35]
    v_mfma_f32_16x16x32_bf16 v[36:39], v[156:159], v[144:147], v[36:39]
    v_mfma_f32_16x16x32_bf16 v[40:43], v[160:163], v[140:143], v[40:43]
    v_mfma_f32_16x16x32_bf16 v[44:47], v[160:163], v[144:147], v[44:47]
    v_mfma_f32_16x16x32_bf16 v[48:51], v[164:167], v[140:143], v[48:51]
    v_mfma_f32_16x16x32_bf16 v[52:55], v[164:167], v[144:147], v[52:55]
    s_barrier
    ds_write_b128 v13, v[16:19] offset:0
    ds_write_b128 v13, v[24:27] offset:64
    ds_write_b128 v13, v[32:35] offset:128
    s_nop 0
    ds_write_b128 v13, v[40:43] offset:192
    s_nop 0
    ds_write_b128 v13, v[48:51] offset:256
    ds_write_b128 v13, v[20:23] offset:5376
    ds_write_b128 v13, v[28:31] offset:5440
    ds_write_b128 v13, v[36:39] offset:5504
    ds_write_b128 v13, v[44:47] offset:5568
    ds_write_b128 v13, v[52:55] offset:5632
.Lk5_epi:
    s_waitcnt lgkmcnt(0)
    s_barrier
    ds_read_b128 v[100:103], v200
    ds_read_b128 v[104:107], v200 offset:16
    ds_read_b128 v[108:111], v200 offset:21504
    ds_read_b128 v[112:115], v200 offset:21520
    ds_read_b128 v[124:127], v201
    ds_read_b128 v[128:131], v201 offset:16
    ds_read_b128 v[132:135], v201 offset:21504
    ds_read_b128 v[136:139], v201 offset:21520
    s_waitcnt vmcnt(0) lgkmcnt(0)
    v_add_f32 v100, v100, v108
    v_add_f32 v101, v101, v109
    v_add_f32 v102, v102, v110
    v_add_f32 v103, v103, v111
    v_add_f32 v104, v104, v112
    v_add_f32 v105, v105, v113
    v_add_f32 v106, v106, v114
    v_add_f32 v107, v107, v115
    v_cvt_pk_bf16_f32 v116, v100, v101
    v_lshlrev_b32 v100, 16, v116
    v_and_b32 v101, 0xffff0000, v116
    v_lshlrev_b32 v116, 16, v208
    v_and_b32 v117, 0xffff0000, v208
    v_add_f32 v100, v100, v116
    v_add_f32 v101, v101, v117
    v_cvt_pk_bf16_f32 v116, v100, v101
    v_lshlrev_b32 v100, 16, v116
    v_and_b32 v101, 0xffff0000, v116
    v_lshlrev_b32 v116, 16, v224
    v_and_b32 v117, 0xffff0000, v224
    v_add_f32 v100, v100, v116
    v_add_f32 v101, v101, v117
    v_cvt_pk_bf16_f32 v120, v100, v101
    v_cvt_pk_bf16_f32 v116, v102, v103
    v_lshlrev_b32 v102, 16, v116
    v_and_b32 v103, 0xffff0000, v116
    v_lshlrev_b32 v116, 16, v209
    v_and_b32 v117, 0xffff0000, v209
    v_add_f32 v102, v102, v116
    v_add_f32 v103, v103, v117
    v_cvt_pk_bf16_f32 v116, v102, v103
    v_lshlrev_b32 v102, 16, v116
    v_and_b32 v103, 0xffff0000, v116
    v_lshlrev_b32 v116, 16, v225
    v_and_b32 v117, 0xffff0000, v225
    v_add_f32 v102, v102, v116
    v_add_f32 v103, v103, v117
    v_cvt_pk_bf16_f32 v121, v102, v103
    v_cvt_pk_bf16_f32 v116, v104, v105
    v_lshlrev_b32 v104, 16, v116
    v_and_b32 v105, 0xffff0000, v116
    v_lshlrev_b32 v116, 16, v210
    v_and_b32 v117, 0xffff0000, v210
    v_add_f32 v104, v104, v116
    v_add_f32 v105, v105, v117
    v_cvt_pk_bf16_f32 v116, v104, v105
    v_lshlrev_b32 v104, 16, v116
    v_and_b32 v105, 0xffff0000, v116
    v_lshlrev_b32 v116, 16, v226
    v_and_b32 v117, 0xffff0000, v226
    v_add_f32 v104, v104, v116
    v_add_f32 v105, v105, v117
    v_cvt_pk_bf16_f32 v122, v104, v105
    v_cvt_pk_bf16_f32 v116, v106, v107
    v_lshlrev_b32 v106, 16, v116
    v_and_b32 v107, 0xffff0000, v116
    v_lshlrev_b32 v116, 16, v211
    v_and_b32 v117, 0xffff0000, v211
    v_add_f32 v106, v106, v116
    v_add_f32 v107, v107, v117
    v_cvt_pk_bf16_f32 v116, v106, v107
    v_lshlrev_b32 v106, 16, v116
    v_and_b32 v107, 0xffff0000, v116
    v_lshlrev_b32 v116, 16, v227
    v_and_b32 v117, 0xffff0000, v227
    v_add_f32 v106, v106, v116
    v_add_f32 v107, v107, v117
    v_cvt_pk_bf16_f32 v123, v106, v107
    buffer_store_dwordx4 v[120:123], v204, s[32:35], 0 offen
    v_add_f32 v124, v124, v132
    v_add_f32 v125, v125, v133
    v_add_f32 v126, v126, v134
    v_add_f32 v127, v127, v135
    v_add_f32 v128, v128, v136
    v_add_f32 v129, v129, v137
    v_add_f32 v130, v130, v138
    v_add_f32 v131, v131, v139
    v_cvt_pk_bf16_f32 v140, v124, v125
    v_lshlrev_b32 v124, 16, v140
    v_and_b32 v125, 0xffff0000, v140
    v_lshlrev_b32 v140, 16, v212
    v_and_b32 v141, 0xffff0000, v212
    v_add_f32 v124, v124, v140
    v_add_f32 v125, v125, v141
    v_cvt_pk_bf16_f32 v140, v124, v125
    v_lshlrev_b32 v124, 16, v140
    v_and_b32 v125, 0xffff0000, v140
    v_lshlrev_b32 v140, 16, v228
    v_and_b32 v141, 0xffff0000, v228
    v_add_f32 v124, v124, v140
    v_add_f32 v125, v125, v141
    v_cvt_pk_bf16_f32 v144, v124, v125
    v_cvt_pk_bf16_f32 v140, v126, v127
    v_lshlrev_b32 v126, 16, v140
    v_and_b32 v127, 0xffff0000, v140
    v_lshlrev_b32 v140, 16, v213
    v_and_b32 v141, 0xffff0000, v213
    v_add_f32 v126, v126, v140
    v_add_f32 v127, v127, v141
    v_cvt_pk_bf16_f32 v140, v126, v127
    v_lshlrev_b32 v126, 16, v140
    v_and_b32 v127, 0xffff0000, v140
    v_lshlrev_b32 v140, 16, v229
    v_and_b32 v141, 0xffff0000, v229
    v_add_f32 v126, v126, v140
    v_add_f32 v127, v127, v141
    v_cvt_pk_bf16_f32 v145, v126, v127
    v_cvt_pk_bf16_f32 v140, v128, v129
    v_lshlrev_b32 v128, 16, v140
    v_and_b32 v129, 0xffff0000, v140
    v_lshlrev_b32 v140, 16, v214
    v_and_b32 v141, 0xffff0000, v214
    v_add_f32 v128, v128, v140
    v_add_f32 v129, v129, v141
    v_cvt_pk_bf16_f32 v140, v128, v129
    v_lshlrev_b32 v128, 16, v140
    v_and_b32 v129, 0xffff0000, v140
    v_lshlrev_b32 v140, 16, v230
    v_and_b32 v141, 0xffff0000, v230
    v_add_f32 v128, v128, v140
    v_add_f32 v129, v129, v141
    v_cvt_pk_bf16_f32 v146, v128, v129
    v_cvt_pk_bf16_f32 v140, v130, v131
    v_lshlrev_b32 v130, 16, v140
    v_and_b32 v131, 0xffff0000, v140
    v_lshlrev_b32 v140, 16, v215
    v_and_b32 v141, 0xffff0000, v215
    v_add_f32 v130, v130, v140
    v_add_f32 v131, v131, v141
    v_cvt_pk_bf16_f32 v140, v130, v131
    v_lshlrev_b32 v130, 16, v140
    v_and_b32 v131, 0xffff0000, v140
    v_lshlrev_b32 v140, 16, v231
    v_and_b32 v141, 0xffff0000, v231
    v_add_f32 v130, v130, v140
    v_add_f32 v131, v131, v141
    v_cvt_pk_bf16_f32 v147, v130, v131
    v_cmp_gt_u32 vcc, 128, v0
    s_and_saveexec_b64 s[10:11], vcc
    buffer_store_dwordx4 v[144:147], v205, s[32:35], 0 offen
    s_mov_b64 exec, s[10:11]
    s_waitcnt vmcnt(0)
.Lk5_end:
    s_endpgm

.section .rodata,"a"
.p2align 6
.amdhsa_kernel k1_rowfft_kernel
  .amdhsa_next_free_vgpr 72
  .amdhsa_next_free_sgpr 102
  .amdhsa_accum_offset 72
  .amdhsa_group_segment_fixed_size 0
  .amdhsa_kernarg_size 88
  .amdhsa_user_sgpr_count 2
  .amdhsa_user_sgpr_kernarg_segment_ptr 1
  .amdhsa_system_sgpr_workgroup_id_x 1
  .amdhsa_float_denorm_mode_32 3
  .amdhsa_float_denorm_mode_16_64 3
.end_amdhsa_kernel
.p2align 6
.amdhsa_kernel k2_colfft_kernel
  .amdhsa_next_free_vgpr 92
  .amdhsa_next_free_sgpr 102
  .amdhsa_accum_offset 92
  .amdhsa_group_segment_fixed_size 0
  .amdhsa_kernarg_size 88
  .amdhsa_user_sgpr_count 2
  .amdhsa_user_sgpr_kernarg_segment_ptr 1
  .amdhsa_system_sgpr_workgroup_id_x 1
  .amdhsa_float_denorm_mode_32 3
  .amdhsa_float_denorm_mode_16_64 3
.end_amdhsa_kernel
.p2align 6
.amdhsa_kernel k3_rowifft_kernel
  .amdhsa_next_free_vgpr 82
  .amdhsa_next_free_sgpr 102
  .amdhsa_accum_offset 84
  .amdhsa_group_segment_fixed_size 0
  .amdhsa_kernarg_size 88
  .amdhsa_user_sgpr_count 2
  .amdhsa_user_sgpr_kernarg_segment_ptr 1
  .amdhsa_system_sgpr_workgroup_id_x 1
  .amdhsa_float_denorm_mode_32 3
  .amdhsa_float_denorm_mode_16_64 3
.end_amdhsa_kernel
.p2align 6
.amdhsa_kernel k4_gemm1_kernel
  .amdhsa_next_free_vgpr 240
  .amdhsa_next_free_sgpr 102
  .amdhsa_accum_offset 240
  .amdhsa_group_segment_fixed_size 0
  .amdhsa_kernarg_size 88
  .amdhsa_user_sgpr_count 2
  .amdhsa_user_sgpr_kernarg_segment_ptr 1
  .amdhsa_system_sgpr_workgroup_id_x 1
  .amdhsa_float_denorm_mode_32 3
  .amdhsa_float_denorm_mode_16_64 3
.end_amdhsa_kernel
.p2align 6
.amdhsa_kernel k5_gemm2_kernel
  .amdhsa_next_free_vgpr 240
  .amdhsa_next_free_sgpr 102
  .amdhsa_accum_offset 240
  .amdhsa_group_segment_fixed_size 0
  .amdhsa_kernarg_size 88
  .amdhsa_user_sgpr_count 2
  .amdhsa_user_sgpr_kernarg_segment_ptr 1
  .amdhsa_system_sgpr_workgroup_id_x 1
  .amdhsa_float_denorm_mode_32 3
  .amdhsa_float_denorm_mode_16_64 3
.end_amdhsa_kernel
```
